```python
import torch

def _softmax(x, axis=-1):
    return torch.softmax(x, dim=axis)
def _gelu(x):
    return torch.nn.functional.gelu(x, approximate="tanh")
def _silu(x):
    return torch.nn.functional.silu(x)
def _sigmoid(x):
    return torch.sigmoid(x)
def _layernorm(x, axis=-1, eps=1e-5):
    m = x.mean(dim=axis, keepdim=True)
    v = x.var(dim=axis, keepdim=True, unbiased=False)
    return (x - m) / torch.sqrt(v + eps)
def _scatter_add(tgt, idx, src, axis=0):
    return tgt.clone().index_add_(axis, idx, src)
def _segment_sum(src, seg, n):
    out = torch.zeros((n,) + src.shape[1:], dtype=src.dtype)
    return out.index_add_(0, seg, src)
def _pad(x, pw):
    flat = tuple(v for pair in reversed(pw) for v in pair)
    return torch.nn.functional.pad(x, flat)

kernel_name = 'concat_heads__sliding_block_cached__gqa_block_cached__decode'

def setup_inputs():

    _w = (lambda a: (lambda t: t.to(torch.bfloat16) if t.is_floating_point() else t)(torch.as_tensor(a)))
    def _A_setup():
        B, Sq, D = 8, 1, 512
        Hq, Hkv, Sk, Dh = 32, 8, 8192, 128
        assert Hq % Hkv == 0, (Hq, Hkv)
        return {
            "x": _w((lambda *s: torch.randn(*s, dtype=torch.bfloat16) * 0.8)(B, Sq, D)),
            "k_cache": _w((lambda *s: torch.randn(*s, dtype=torch.bfloat16) * 1.6)(B, Hkv, Sk, Dh)),
            "v_cache": _w((lambda *s: torch.randn(*s, dtype=torch.bfloat16) * 0.2)(B, Hkv, Sk, Dh)),
            "wq": _w((lambda *s: torch.randn(*s, dtype=torch.bfloat16) * 1.6)(D, Hq * Dh) * (D ** -0.5)),
            "wo": _w((lambda *s: torch.randn(*s, dtype=torch.bfloat16) * 0.2)(Hq * Dh, D) * ((Hq * Dh) ** -0.5)),
        }
    _A_in = _A_setup()

    def _B_setup():
        B, Sq, D = 8, 1, 512
        Hq, Hkv, Sk, Dh = 32, 8, 8192, 128
        assert Hq % Hkv == 0, (Hq, Hkv)
        return {
            "x": _w((lambda *s: torch.randn(*s, dtype=torch.bfloat16) * 0.8)(B, Sq, D)),
            "k_cache": _w((lambda *s: torch.randn(*s, dtype=torch.bfloat16) * 1.6)(B, Hkv, Sk, Dh)),
            "v_cache": _w((lambda *s: torch.randn(*s, dtype=torch.bfloat16) * 0.2)(B, Hkv, Sk, Dh)),
            "wq": _w((lambda *s: torch.randn(*s, dtype=torch.bfloat16) * 1.6)(D, Hq * Dh) * (D ** -0.5)),
            "wo": _w((lambda *s: torch.randn(*s, dtype=torch.bfloat16) * 0.2)(Hq * Dh, D) * ((Hq * Dh) ** -0.5)),
        }
    _B_in = _B_setup()

    return {
        "A_x": _A_in["x"],
        "A_k_cache": _A_in["k_cache"],
        "A_v_cache": _A_in["v_cache"],
        "A_wq": _A_in["wq"],
        "A_wo": _A_in["wo"],
        "B_x": _B_in["x"],
        "B_k_cache": _B_in["k_cache"],
        "B_v_cache": _B_in["v_cache"],
        "B_wq": _B_in["wq"],
        "B_wo": _B_in["wo"],
    }

def reference(A_x, A_k_cache, A_v_cache, A_wq, A_wo, B_x, B_k_cache, B_v_cache, B_wq, B_wo):
    def _A_ref(x, k_cache, v_cache, wq, wo):
        B, Sq, D = x.shape
        Hq, Dh = 32, 128
        Hkv, Sk = k_cache.shape[1], k_cache.shape[2]
        W = min(4096, max(256, Sk // 4))
        rep = Hq // Hkv
        q = (lambda x, *d: x.permute(*d))((x @ wq).reshape(B, Sq, Hq, Dh), 0, 2, 1, 3)
        k = (lambda x, n, axis: torch.repeat_interleave(x, n, dim=axis))(k_cache[:, :, Sk - W:, :], rep, axis=1)
        v = (lambda x, n, axis: torch.repeat_interleave(x, n, dim=axis))(v_cache[:, :, Sk - W:, :], rep, axis=1)
        scores = torch.einsum("bhqd,bhkd->bhqk", q, k) * (Dh ** -0.5)
        p = _softmax(scores, axis=-1)
        o = torch.einsum("bhqk,bhkd->bhqd", p, v)
        return (lambda x, *d: x.permute(*d))(o, 0, 2, 1, 3).reshape(B, Sq, Hq * Dh) @ wo

    def _B_ref(x, k_cache, v_cache, wq, wo):
        B, Sq, D = x.shape
        Hq, Dh = 32, 128
        Hkv = k_cache.shape[1]
        rep = Hq // Hkv
        q = (lambda x, *d: x.permute(*d))((x @ wq).reshape(B, Sq, Hq, Dh), 0, 2, 1, 3)
        k = (lambda x, n, axis: torch.repeat_interleave(x, n, dim=axis))(k_cache, rep, axis=1)
        v = (lambda x, n, axis: torch.repeat_interleave(x, n, dim=axis))(v_cache, rep, axis=1)
        scores = torch.einsum("bhqd,bhkd->bhqk", q, k) * (Dh ** -0.5)
        p = _softmax(scores, axis=-1)
        o = torch.einsum("bhqk,bhkd->bhqd", p, v)
        return (lambda x, *d: x.permute(*d))(o, 0, 2, 1, 3).reshape(B, Sq, Hq * Dh) @ wo

    a = _A_ref(A_x, A_k_cache, A_v_cache, A_wq, A_wo)
    b = _B_ref(B_x, B_k_cache, B_v_cache, B_wq, B_wo)
    return torch.concatenate([a, b], axis=-1)
```

```asm
; @launch grid=(256,1,1) block=(256,1,1) lds=50704
.amdgcn_target "amdgcn-amd-amdhsa--gfx950"
.text
.globl concat_heads__sliding_block_cached__gqa_block_cached__decode_kernel
.p2align 8
.type concat_heads__sliding_block_cached__gqa_block_cached__decode_kernel,@function
concat_heads__sliding_block_cached__gqa_block_cached__decode_kernel:
  s_cmp_ge_u32 s2, 256
  s_cbranch_scc1 L_end
  s_load_dwordx16 s[4:19], s[0:1], 0
  s_load_dwordx8 s[20:27], s[0:1], 64
  s_load_dwordx2 s[28:29], s[0:1], 96
  s_getpc_b64 s[30:31]
L_pc:
  v_lshlrev_b32 v15, 7, v0
  v_min_u32 v15, L_end-L_pc, v15
  global_load_dword v16, v15, s[30:31]
  v_and_b32 v1, 63, v0
  v_lshrrev_b32 v11, 6, v0
  v_mov_b32 v19, 0
  v_readfirstlane_b32 s52, v11
  v_bfe_u32 v12, v1, 2, 2
  v_lshrrev_b32 v13, 4, v1
  v_and_b32 v14, 3, v1
  v_and_b32 v6, 15, v1
  v_lshlrev_b32 v3, 4, v1
  v_lshlrev_b32 v2, 8, v12
  v_lshl_add_u32 v2, v13, 6, v2
  v_lshl_add_u32 v2, v14, 4, v2
  v_lshlrev_b32 v68, 16, v13
  v_lshl_add_u32 v68, v6, 4, v68
  v_lshlrev_b32 v69, 10, v14
  v_lshl_add_u32 v69, v13, 4, v69
  s_and_b32 s30, s2, 3
  s_lshr_b32 s74, s2, 2
  s_lshr_b32 s70, s74, 3
  s_and_b32 s71, s74, 7
  s_and_b32 s72, s2, 3
  s_lshl_b32 s96, s74, 8
  s_add_u32 s96, s96, 32768
  s_lshl_b32 s74, s74, 21
  s_lshl_b32 s63, s30, 2
  s_add_u32 s63, s63, s52
  s_lshl_b32 s62, s63, 12
  s_add_u32 s54, s74, s62
  s_lshl_b32 s63, s72, 2
  s_add_u32 s63, s63, s52
  s_lshl_b32 s62, s52, 12
  s_add_u32 s53, s74, s62
  s_lshl_b32 s62, s30, 17
  s_add_u32 s53, s53, s62
  s_add_u32 s53, s53, 1572864
  s_lshl_b32 s64, s63, 18
  s_bfe_u32 s65, s2, 0x50002
  s_lshl_b32 s65, s65, 8
  s_add_u32 s64, s64, s65
  s_lshl_b32 s63, s63, 6
  s_waitcnt lgkmcnt(0)
  s_mov_b32 s40, s28
  s_and_b32 s41, s29, 0xffff
  s_mov_b32 s42, 0x600000
  s_mov_b32 s43, 0x20000
  buffer_load_dword v5, v19, s[40:43], 0 offen offset:0 sc1
  s_and_b32 s62, s2, 0x8f
  s_or_b32 s62, s62, s52
  s_cmp_lg_u32 s62, 0
  s_cbranch_scc1 L_nocnt
  s_lshr_b32 s62, s2, 4
  s_lshl_b32 s62, s62, 8
  s_add_u32 s62, s62, 32768
  v_lshlrev_b32 v15, 11, v1
  s_mov_b64 exec, 0xff
  buffer_store_dword v19, v15, s[40:43], s62 offen sc1
  s_lshr_b32 s62, s2, 4
  s_lshl_b32 s65, s62, 11
  s_add_u32 s65, s65, 49152
  v_lshlrev_b32 v15, 8, v1
  buffer_store_dword v19, v15, s[40:43], s65 offen sc1
  s_lshl_b32 s65, s62, 8
  s_add_u32 s65, s65, 4325376
  v_lshlrev_b32 v15, 11, v1
  s_mov_b64 exec, 0xf
  buffer_store_dword v19, v15, s[40:43], s65 offen sc1
  s_mov_b64 exec, -1
L_nocnt:
  s_cmp_lt_u32 s2, 128
  s_cselect_b32 s44, s4, s14
  s_cselect_b32 s45, s5, s15
  s_cselect_b32 s48, s10, s20
  s_cselect_b32 s49, s11, s21
  s_and_b32 s45, s45, 0xffff
  s_and_b32 s49, s49, 0xffff
  s_mov_b32 s46, 8192
  s_mov_b32 s47, 0x20000
  s_mov_b32 s50, 0x400000
  s_mov_b32 s51, 0x20000
  buffer_load_dwordx4 v[70:73], v69, s[44:47], s63 offen
  s_add_u32 s63, s63, 4096
  buffer_load_dwordx4 v[74:77], v69, s[44:47], s63 offen
  buffer_load_dwordx4 a[96:99], v68, s[48:51], s64 offen nt
  s_add_u32 s64, s64, 8192
  buffer_load_dwordx4 a[100:103], v68, s[48:51], s64 offen nt
  s_add_u32 s64, s64, 8192
  buffer_load_dwordx4 a[104:107], v68, s[48:51], s64 offen nt
  s_add_u32 s64, s64, 8192
  buffer_load_dwordx4 a[108:111], v68, s[48:51], s64 offen nt
  s_add_u32 s64, s64, 8192
  buffer_load_dwordx4 a[112:115], v68, s[48:51], s64 offen nt
  s_add_u32 s64, s64, 8192
  buffer_load_dwordx4 a[116:119], v68, s[48:51], s64 offen nt
  s_add_u32 s64, s64, 8192
  buffer_load_dwordx4 a[120:123], v68, s[48:51], s64 offen nt
  s_add_u32 s64, s64, 8192
  buffer_load_dwordx4 a[124:127], v68, s[48:51], s64 offen nt
  s_mov_b32 s32, s6
  s_and_b32 s33, s7, 0xffff
  s_mov_b32 s34, 0x8000000
  s_mov_b32 s35, 0x20000
  s_mov_b32 s36, s8
  s_and_b32 s37, s9, 0xffff
  s_mov_b32 s38, 0x8000000
  s_mov_b32 s39, 0x20000
  s_mov_b32 s55, 0
  s_mov_b32 s69, 16384
  s_and_b32 s17, s17, 0xffff
  s_and_b32 s19, s19, 0xffff
  s_mov_b32 s59, 0x3e0293ee
  s_mov_b32 s60, 0xff
  s_mov_b32 s61, 0xffffff00
  v_mul_u32_u24 v4, 196, v14
  v_mad_u32_u24 v4, v13, 48, v4
  v_add_lshl_u32 v4, v4, v12, 2
  v_lshrrev_b32 v9, 5, v0
  v_mul_u32_u24 v9, 196, v9
  v_bfe_u32 v15, v0, 3, 2
  v_mad_u32_u24 v9, v15, 48, v9
  v_and_b32 v15, 7, v0
  v_lshl_add_u32 v9, v15, 2, v9
  v_lshlrev_b32 v9, 2, v9
  v_mov_b32 v78, 0xc0c0c0c
  v_mov_b32 v15, 0xc0c0100
  v_cmp_eq_u32 vcc, 0, v12
  s_nop 1
  v_cndmask_b32 v78, v78, v15, vcc
  v_mov_b32 v15, 0x1000c0c
  v_cmp_eq_u32 vcc, 1, v12
  s_nop 1
  v_cndmask_b32 v78, v78, v15, vcc
  v_mov_b32 v79, 0xc0c0c0c
  v_mov_b32 v15, 0xc0c0302
  v_cmp_eq_u32 vcc, 0, v12
  s_nop 1
  v_cndmask_b32 v79, v79, v15, vcc
  v_mov_b32 v15, 0x3020c0c
  v_cmp_eq_u32 vcc, 1, v12
  s_nop 1
  v_cndmask_b32 v79, v79, v15, vcc
  v_mov_b32 v80, 0xc0c0c0c
  v_mov_b32 v15, 0xc0c0100
  v_cmp_eq_u32 vcc, 2, v12
  s_nop 1
  v_cndmask_b32 v80, v80, v15, vcc
  v_mov_b32 v15, 0x1000c0c
  v_cmp_eq_u32 vcc, 3, v12
  s_nop 1
  v_cndmask_b32 v80, v80, v15, vcc
  v_mov_b32 v81, 0xc0c0c0c
  v_mov_b32 v15, 0xc0c0302
  v_cmp_eq_u32 vcc, 2, v12
  s_nop 1
  v_cndmask_b32 v81, v81, v15, vcc
  v_mov_b32 v15, 0x3020c0c
  v_cmp_eq_u32 vcc, 3, v12
  s_nop 1
  v_cndmask_b32 v81, v81, v15, vcc
  v_mov_b32 v17, 0x0
  v_mov_b32 v15, 0xffff
  v_cmp_eq_u32 vcc, 0, v12
  s_nop 1
  v_cndmask_b32 v17, v17, v15, vcc
  v_mov_b32 v15, 0xffff0000
  v_cmp_eq_u32 vcc, 1, v12
  s_nop 1
  v_cndmask_b32 v17, v17, v15, vcc
  v_mov_b32 v18, 0x0
  v_mov_b32 v15, 0xffff
  v_cmp_eq_u32 vcc, 2, v12
  s_nop 1
  v_cndmask_b32 v18, v18, v15, vcc
  v_mov_b32 v15, 0xffff0000
  v_cmp_eq_u32 vcc, 3, v12
  s_nop 1
  v_cndmask_b32 v18, v18, v15, vcc
  v_mov_b32 v44, 0
  v_mov_b32 v45, 0
  v_mov_b32 v46, 0
  v_mov_b32 v47, 0
  v_mov_b32 v48, 0
  v_mov_b32 v49, 0
  v_mov_b32 v50, 0
  v_mov_b32 v51, 0
  v_lshlrev_b32 v15, 2, v1
  s_mov_b64 exec, 3
  ds_write_b32 v15, v19 offset:50688
  s_mov_b64 exec, -1
  s_waitcnt vmcnt(7)
  v_add_u32 v5, 1, v5
  v_perm_b32 v100, v70, v70, v78
  v_perm_b32 v101, v70, v70, v80
  v_perm_b32 v102, v74, v74, v78
  v_perm_b32 v103, v74, v74, v80
  v_mfma_f32_16x16x16_bf16 v[84:87], a[96:97], v[100:101], 0
  v_mfma_f32_16x16x16_bf16 v[88:91], a[98:99], v[100:101], 0
  v_mfma_f32_16x16x16_bf16 v[92:95], a[96:97], v[102:103], 0
  v_mfma_f32_16x16x16_bf16 v[96:99], a[98:99], v[102:103], 0
  s_waitcnt vmcnt(6)
  v_perm_b32 v104, v70, v70, v79
  v_perm_b32 v105, v70, v70, v81
  v_perm_b32 v106, v74, v74, v79
  v_perm_b32 v107, v74, v74, v81
  v_mfma_f32_16x16x16_bf16 v[84:87], a[100:101], v[104:105], v[84:87]
  v_mfma_f32_16x16x16_bf16 v[88:91], a[102:103], v[104:105], v[88:91]
  v_mfma_f32_16x16x16_bf16 v[92:95], a[100:101], v[106:107], v[92:95]
  v_mfma_f32_16x16x16_bf16 v[96:99], a[102:103], v[106:107], v[96:99]
  s_waitcnt vmcnt(5)
  buffer_load_dwordx4 a[0:3], v2, s[32:35], s53 offen offset:0 nt
  buffer_load_dwordx4 a[4:7], v2, s[32:35], s53 offen offset:1024 nt
  buffer_load_dwordx4 a[8:11], v2, s[32:35], s53 offen offset:2048 nt
  buffer_load_dwordx4 a[12:15], v2, s[32:35], s53 offen offset:3072 nt
  buffer_load_dwordx4 a[16:19], v3, s[36:39], s53 offen offset:0 nt
  buffer_load_dwordx4 a[20:23], v3, s[36:39], s53 offen offset:1024 nt
  buffer_load_dwordx4 a[24:27], v3, s[36:39], s53 offen offset:2048 nt
  buffer_load_dwordx4 a[28:31], v3, s[36:39], s53 offen offset:3072 nt
  s_add_u32 s53, s53, s69
  s_add_u32 s55, s55, 1
  s_cmp_eq_u32 s55, 8
  s_cselect_b32 s53, s54, s53
  s_cselect_b32 s69, 0x10000, s69
  s_cselect_b32 s32, s16, s32
  s_cselect_b32 s33, s17, s33
  s_cselect_b32 s36, s18, s36
  s_cselect_b32 s37, s19, s37
  v_perm_b32 v100, v71, v71, v78
  v_perm_b32 v101, v71, v71, v80
  v_perm_b32 v102, v75, v75, v78
  v_perm_b32 v103, v75, v75, v80
  v_mfma_f32_16x16x16_bf16 v[84:87], a[104:105], v[100:101], v[84:87]
  v_mfma_f32_16x16x16_bf16 v[88:91], a[106:107], v[100:101], v[88:91]
  v_mfma_f32_16x16x16_bf16 v[92:95], a[104:105], v[102:103], v[92:95]
  v_mfma_f32_16x16x16_bf16 v[96:99], a[106:107], v[102:103], v[96:99]
  s_waitcnt vmcnt(12)
  v_perm_b32 v104, v71, v71, v79
  v_perm_b32 v105, v71, v71, v81
  v_perm_b32 v106, v75, v75, v79
  v_perm_b32 v107, v75, v75, v81
  v_mfma_f32_16x16x16_bf16 v[84:87], a[108:109], v[104:105], v[84:87]
  v_mfma_f32_16x16x16_bf16 v[88:91], a[110:111], v[104:105], v[88:91]
  v_mfma_f32_16x16x16_bf16 v[92:95], a[108:109], v[106:107], v[92:95]
  v_mfma_f32_16x16x16_bf16 v[96:99], a[110:111], v[106:107], v[96:99]
  s_waitcnt vmcnt(11)
  v_perm_b32 v100, v72, v72, v78
  v_perm_b32 v101, v72, v72, v80
  v_perm_b32 v102, v76, v76, v78
  v_perm_b32 v103, v76, v76, v80
  v_mfma_f32_16x16x16_bf16 v[84:87], a[112:113], v[100:101], v[84:87]
  v_mfma_f32_16x16x16_bf16 v[88:91], a[114:115], v[100:101], v[88:91]
  v_mfma_f32_16x16x16_bf16 v[92:95], a[112:113], v[102:103], v[92:95]
  v_mfma_f32_16x16x16_bf16 v[96:99], a[114:115], v[102:103], v[96:99]
  s_waitcnt vmcnt(10)
  v_perm_b32 v104, v72, v72, v79
  v_perm_b32 v105, v72, v72, v81
  v_perm_b32 v106, v76, v76, v79
  v_perm_b32 v107, v76, v76, v81
  v_mfma_f32_16x16x16_bf16 v[84:87], a[116:117], v[104:105], v[84:87]
  v_mfma_f32_16x16x16_bf16 v[88:91], a[118:119], v[104:105], v[88:91]
  v_mfma_f32_16x16x16_bf16 v[92:95], a[116:117], v[106:107], v[92:95]
  v_mfma_f32_16x16x16_bf16 v[96:99], a[118:119], v[106:107], v[96:99]
  s_waitcnt vmcnt(9)
  v_perm_b32 v100, v73, v73, v78
  v_perm_b32 v101, v73, v73, v80
  v_perm_b32 v102, v77, v77, v78
  v_perm_b32 v103, v77, v77, v80
  v_mfma_f32_16x16x16_bf16 v[84:87], a[120:121], v[100:101], v[84:87]
  v_mfma_f32_16x16x16_bf16 v[88:91], a[122:123], v[100:101], v[88:91]
  v_mfma_f32_16x16x16_bf16 v[92:95], a[120:121], v[102:103], v[92:95]
  v_mfma_f32_16x16x16_bf16 v[96:99], a[122:123], v[102:103], v[96:99]
  s_waitcnt vmcnt(8)
  v_perm_b32 v104, v73, v73, v79
  v_perm_b32 v105, v73, v73, v81
  v_perm_b32 v106, v77, v77, v79
  v_perm_b32 v107, v77, v77, v81
  v_mfma_f32_16x16x16_bf16 v[84:87], a[124:125], v[104:105], v[84:87]
  v_mfma_f32_16x16x16_bf16 v[88:91], a[126:127], v[104:105], v[88:91]
  v_mfma_f32_16x16x16_bf16 v[92:95], a[124:125], v[106:107], v[92:95]
  v_mfma_f32_16x16x16_bf16 v[96:99], a[126:127], v[106:107], v[96:99]
  s_mul_i32 s62, s52, 6272
  v_add_u32 v15, s62, v4
  s_lshr_b32 s62, s2, 4
  s_lshl_b32 s62, s62, 2
  s_add_u32 s62, s62, s72
  s_lshl_b32 s62, s62, 14
  s_bfe_u32 s63, s2, 0x20002
  s_lshl_b32 s63, s63, 9
  s_add_u32 s62, s62, s63
  s_add_u32 s62, s62, 65536
  ds_write_b32 v15, v84 offset:0
  ds_write_b32 v15, v85 offset:32
  ds_write_b32 v15, v86 offset:64
  ds_write_b32 v15, v87 offset:96
  ds_write_b32 v15, v88 offset:16
  ds_write_b32 v15, v89 offset:48
  ds_write_b32 v15, v90 offset:80
  ds_write_b32 v15, v91 offset:112
  ds_write_b32 v15, v92 offset:3136
  ds_write_b32 v15, v93 offset:3168
  ds_write_b32 v15, v94 offset:3200
  ds_write_b32 v15, v95 offset:3232
  ds_write_b32 v15, v96 offset:3152
  ds_write_b32 v15, v97 offset:3184
  ds_write_b32 v15, v98 offset:3216
  ds_write_b32 v15, v99 offset:3248
  v_lshrrev_b32 v15, 5, v0
  v_lshlrev_b32 v15, 11, v15
  v_and_b32 v16, 31, v0
  v_lshl_add_u32 v15, v16, 4, v15
  s_waitcnt lgkmcnt(0)
  s_barrier
  ds_read_b128 v[112:115], v9 offset:0
  ds_read_b128 v[116:119], v9 offset:6272
  ds_read_b128 v[120:123], v9 offset:12544
  ds_read_b128 v[124:127], v9 offset:18816
  v_lshlrev_b32 v109, 9, v14
  v_lshl_add_u32 v109, v13, 7, v109
  v_lshl_add_u32 v109, v12, 5, v109
  s_lshl_b32 s64, s71, 2
  s_add_u32 s64, s64, s52
  s_lshl_b32 s64, s64, 3
  s_add_u32 s64, s64, s70
  s_lshl_b32 s64, s64, 11
  s_add_u32 s100, s64, 65536
  s_add_u32 s101, s100, 0x80000
  s_waitcnt lgkmcnt(0)
  v_add_f32 v112, v112, v116
  v_add_f32 v120, v120, v124
  v_add_f32 v113, v113, v117
  v_add_f32 v121, v121, v125
  v_add_f32 v114, v114, v118
  v_add_f32 v122, v122, v126
  v_add_f32 v115, v115, v119
  v_add_f32 v123, v123, v127
  v_add_f32 v112, v112, v120
  v_add_f32 v113, v113, v121
  v_add_f32 v114, v114, v122
  v_add_f32 v115, v115, v123
  v_bfi_b32 v112, s60, v5, v112
  v_bfi_b32 v113, s60, v5, v113
  v_bfi_b32 v114, s60, v5, v114
  v_bfi_b32 v115, s60, v5, v115
  buffer_store_dwordx4 v[112:115], v15, s[40:43], s62 offen sc1
  s_mov_b32 s58, 0
  buffer_load_dwordx4 a[32:35], v2, s[32:35], s53 offen offset:0 nt
  buffer_load_dwordx4 a[36:39], v2, s[32:35], s53 offen offset:1024 nt
  buffer_load_dwordx4 a[40:43], v2, s[32:35], s53 offen offset:2048 nt
  buffer_load_dwordx4 a[44:47], v2, s[32:35], s53 offen offset:3072 nt
  buffer_load_dwordx4 a[48:51], v3, s[36:39], s53 offen offset:0 nt
  buffer_load_dwordx4 a[52:55], v3, s[36:39], s53 offen offset:1024 nt
  buffer_load_dwordx4 a[56:59], v3, s[36:39], s53 offen offset:2048 nt
  buffer_load_dwordx4 a[60:63], v3, s[36:39], s53 offen offset:3072 nt
  s_add_u32 s53, s53, s69
  s_add_u32 s55, s55, 1
  s_cmp_eq_u32 s55, 8
  s_cselect_b32 s53, s54, s53
  s_cselect_b32 s69, 0x10000, s69
  s_cselect_b32 s32, s16, s32
  s_cselect_b32 s33, s17, s33
  s_cselect_b32 s36, s18, s36
  s_cselect_b32 s37, s19, s37
  buffer_load_dwordx4 v[84:87], v109, s[40:43], s100 offen sc1
  buffer_load_dwordx4 v[88:91], v109, s[40:43], s100 offen offset:16 sc1
  buffer_load_dwordx4 v[92:95], v109, s[40:43], s101 offen sc1
  buffer_load_dwordx4 v[96:99], v109, s[40:43], s101 offen offset:16 sc1
  buffer_load_dwordx4 a[64:67], v2, s[32:35], s53 offen offset:0 nt
  buffer_load_dwordx4 a[68:71], v2, s[32:35], s53 offen offset:1024 nt
  buffer_load_dwordx4 a[72:75], v2, s[32:35], s53 offen offset:2048 nt
  buffer_load_dwordx4 a[76:79], v2, s[32:35], s53 offen offset:3072 nt
  buffer_load_dwordx4 a[80:83], v3, s[36:39], s53 offen offset:0 nt
  buffer_load_dwordx4 a[84:87], v3, s[36:39], s53 offen offset:1024 nt
  buffer_load_dwordx4 a[88:91], v3, s[36:39], s53 offen offset:2048 nt
  buffer_load_dwordx4 a[92:95], v3, s[36:39], s53 offen offset:3072 nt
  s_add_u32 s53, s53, s69
  s_add_u32 s55, s55, 1
  s_cmp_eq_u32 s55, 8
  s_cselect_b32 s53, s54, s53
  s_cselect_b32 s69, 0x10000, s69
  s_cselect_b32 s32, s16, s32
  s_cselect_b32 s33, s17, s33
  s_cselect_b32 s36, s18, s36
  s_cselect_b32 s37, s19, s37
  v_mov_b32 v28, 0
  v_mov_b32 v29, 0
  v_mov_b32 v30, 0
  v_mov_b32 v31, 0
  v_mov_b32 v32, 0
  v_mov_b32 v33, 0
  v_mov_b32 v34, 0
  v_mov_b32 v35, 0
  v_mov_b32 v6, 0xff800000
  v_mov_b32 v7, 0xff800000
  v_mov_b32 v8, 0
  v_and_b32 v15, 3, v1
  v_bfe_u32 v16, v1, 2, 2
  v_lshlrev_b32 v36, 13, v15
  v_lshl_add_u32 v36, v16, 11, v36
  v_lshlrev_b32 v37, 7, v15
  v_lshl_add_u32 v37, v16, 5, v37
  v_lshrrev_b32 v15, 4, v1
  v_lshl_add_u32 v36, v15, 4, v36
  v_lshlrev_b32 v39, 12, v15
  v_and_b32 v16, 15, v1
  v_lshl_add_u32 v39, v16, 4, v39
  s_lshr_b32 s62, s2, 5
  s_bfe_u32 s63, s2, 0x20003
  s_bfe_u32 s64, s2, 0x10002
  s_lshl_b32 s65, s62, 16
  s_lshl_b32 s66, s63, 9
  s_add_u32 s65, s65, s66
  s_lshl_b32 s66, s64, 8
  s_add_u32 s65, s65, s66
  s_lshl_b32 s66, s52, 6
  s_add_u32 s65, s65, s66
  s_add_u32 s97, s65, 1114112
  s_lshl_b32 s66, s62, 10
  s_lshl_b32 s67, s63, 3
  s_add_u32 s66, s66, s67
  s_add_u32 s98, s66, 2162688
  v_lshrrev_b32 v38, 5, v0
  v_lshlrev_b32 v38, 9, v38
  v_and_b32 v15, 31, v0
  v_lshl_add_u32 v38, v15, 4, v38
  s_lshr_b32 s62, s2, 2
  s_lshl_b32 s63, s72, 6
  s_add_u32 s63, s62, s63
  s_lshl_b32 s63, s63, 12
  s_add_u32 s99, s63, 2228224
  s_lshl_b32 s62, s62, 2
  s_add_u32 s62, s62, s52
  s_lshl_b32 s62, s62, 14
  s_lshl_b32 s63, s72, 8
  s_add_u32 s26, s62, s63
  s_mov_b32 s44, s12
  s_and_b32 s45, s13, 0xffff
  s_mov_b32 s46, 0x400000
  s_mov_b32 s47, 0x20000
  s_mov_b32 s48, s22
  s_and_b32 s49, s23, 0xffff
  s_mov_b32 s50, 0x400000
  s_mov_b32 s51, 0x20000
  s_lshl_b32 s20, s71, 11
  s_add_u32 s20, s20, 49152
  s_lshr_b32 s21, s2, 5
  s_lshl_b32 s21, s21, 3
  s_and_b32 s62, s2, 1
  s_lshl_b32 s62, s62, 2
  s_add_u32 s62, s62, s52
  s_add_u32 s21, s21, s62
  s_lshl_b32 s21, s21, 8
  s_add_u32 s21, s21, 49152
  s_lshl_b32 s9, s72, 3
  s_add_u32 s9, s9, s71
  s_lshl_b32 s9, s9, 8
  s_add_u32 s9, s9, 4325376
  s_mov_b32 s56, 2
  s_waitcnt vmcnt(8)
  v_xor_b32 v15, v84, v5
  v_bitop3_b32 v15, v15, v85, v5 bitop3:0xf6
  v_bitop3_b32 v15, v15, v86, v5 bitop3:0xf6
  v_bitop3_b32 v15, v15, v87, v5 bitop3:0xf6
  v_bitop3_b32 v15, v15, v88, v5 bitop3:0xf6
  v_bitop3_b32 v15, v15, v89, v5 bitop3:0xf6
  v_bitop3_b32 v15, v15, v90, v5 bitop3:0xf6
  v_bitop3_b32 v15, v15, v91, v5 bitop3:0xf6
  v_bitop3_b32 v15, v15, v92, v5 bitop3:0xf6
  v_bitop3_b32 v15, v15, v93, v5 bitop3:0xf6
  v_bitop3_b32 v15, v15, v94, v5 bitop3:0xf6
  v_bitop3_b32 v15, v15, v95, v5 bitop3:0xf6
  v_bitop3_b32 v15, v15, v96, v5 bitop3:0xf6
  v_bitop3_b32 v15, v15, v97, v5 bitop3:0xf6
  v_bitop3_b32 v15, v15, v98, v5 bitop3:0xf6
  v_bitop3_b32 v15, v15, v99, v5 bitop3:0xf6
  v_and_b32 v15, 0xff, v15
  v_cmp_ne_u32 vcc, 0, v15
  s_cbranch_vccz L_qok2
  buffer_load_dwordx4 v[84:87], v109, s[40:43], s100 offen sc1
  buffer_load_dwordx4 v[88:91], v109, s[40:43], s100 offen offset:16 sc1
  buffer_load_dwordx4 v[92:95], v109, s[40:43], s101 offen sc1
  buffer_load_dwordx4 v[96:99], v109, s[40:43], s101 offen offset:16 sc1
  buffer_load_dwordx4 a[96:99], v2, s[32:35], s53 offen offset:0 nt
  buffer_load_dwordx4 a[100:103], v2, s[32:35], s53 offen offset:1024 nt
  buffer_load_dwordx4 a[104:107], v2, s[32:35], s53 offen offset:2048 nt
  buffer_load_dwordx4 a[108:111], v2, s[32:35], s53 offen offset:3072 nt
  buffer_load_dwordx4 a[112:115], v3, s[36:39], s53 offen offset:0 nt
  buffer_load_dwordx4 a[116:119], v3, s[36:39], s53 offen offset:1024 nt
  buffer_load_dwordx4 a[120:123], v3, s[36:39], s53 offen offset:2048 nt
  buffer_load_dwordx4 a[124:127], v3, s[36:39], s53 offen offset:3072 nt
  s_add_u32 s53, s53, s69
  s_add_u32 s55, s55, 1
  s_cmp_eq_u32 s55, 8
  s_cselect_b32 s53, s54, s53
  s_cselect_b32 s69, 0x10000, s69
  s_cselect_b32 s32, s16, s32
  s_cselect_b32 s33, s17, s33
  s_cselect_b32 s36, s18, s36
  s_cselect_b32 s37, s19, s37
  s_mov_b32 s56, 3
  s_waitcnt vmcnt(8)
  v_xor_b32 v15, v84, v5
  v_bitop3_b32 v15, v15, v85, v5 bitop3:0xf6
  v_bitop3_b32 v15, v15, v86, v5 bitop3:0xf6
  v_bitop3_b32 v15, v15, v87, v5 bitop3:0xf6
  v_bitop3_b32 v15, v15, v88, v5 bitop3:0xf6
  v_bitop3_b32 v15, v15, v89, v5 bitop3:0xf6
  v_bitop3_b32 v15, v15, v90, v5 bitop3:0xf6
  v_bitop3_b32 v15, v15, v91, v5 bitop3:0xf6
  v_bitop3_b32 v15, v15, v92, v5 bitop3:0xf6
  v_bitop3_b32 v15, v15, v93, v5 bitop3:0xf6
  v_bitop3_b32 v15, v15, v94, v5 bitop3:0xf6
  v_bitop3_b32 v15, v15, v95, v5 bitop3:0xf6
  v_bitop3_b32 v15, v15, v96, v5 bitop3:0xf6
  v_bitop3_b32 v15, v15, v97, v5 bitop3:0xf6
  v_bitop3_b32 v15, v15, v98, v5 bitop3:0xf6
  v_bitop3_b32 v15, v15, v99, v5 bitop3:0xf6
  v_and_b32 v15, 0xff, v15
  v_cmp_ne_u32 vcc, 0, v15
  s_cbranch_vccz L_qok3
  s_mov_b32 s56, 4
  s_mov_b32 s58, 1
  buffer_load_dwordx4 v[84:87], v109, s[40:43], s100 offen sc1
  buffer_load_dwordx4 v[88:91], v109, s[40:43], s100 offen offset:16 sc1
  buffer_load_dwordx4 v[92:95], v109, s[40:43], s101 offen sc1
  buffer_load_dwordx4 v[96:99], v109, s[40:43], s101 offen offset:16 sc1
  s_waitcnt vmcnt(0)
  s_mov_b32 s68, 0x40000
L_qp_chk:
  v_xor_b32 v15, v84, v5
  v_bitop3_b32 v15, v15, v85, v5 bitop3:0xf6
  v_bitop3_b32 v15, v15, v86, v5 bitop3:0xf6
  v_bitop3_b32 v15, v15, v87, v5 bitop3:0xf6
  v_bitop3_b32 v15, v15, v88, v5 bitop3:0xf6
  v_bitop3_b32 v15, v15, v89, v5 bitop3:0xf6
  v_bitop3_b32 v15, v15, v90, v5 bitop3:0xf6
  v_bitop3_b32 v15, v15, v91, v5 bitop3:0xf6
  v_bitop3_b32 v15, v15, v92, v5 bitop3:0xf6
  v_bitop3_b32 v15, v15, v93, v5 bitop3:0xf6
  v_bitop3_b32 v15, v15, v94, v5 bitop3:0xf6
  v_bitop3_b32 v15, v15, v95, v5 bitop3:0xf6
  v_bitop3_b32 v15, v15, v96, v5 bitop3:0xf6
  v_bitop3_b32 v15, v15, v97, v5 bitop3:0xf6
  v_bitop3_b32 v15, v15, v98, v5 bitop3:0xf6
  v_bitop3_b32 v15, v15, v99, v5 bitop3:0xf6
  v_and_b32 v15, 0xff, v15
  v_cmp_ne_u32 vcc, 0, v15
  s_cbranch_vccz L_qp_ok
  s_sub_u32 s68, s68, 1
  s_cmp_eq_u32 s68, 0
  s_cbranch_scc1 L_qp_ok
  s_mov_b64 exec, vcc
  buffer_load_dwordx4 v[84:87], v109, s[40:43], s100 offen sc1
  buffer_load_dwordx4 v[88:91], v109, s[40:43], s100 offen offset:16 sc1
  buffer_load_dwordx4 v[92:95], v109, s[40:43], s101 offen sc1
  buffer_load_dwordx4 v[96:99], v109, s[40:43], s101 offen offset:16 sc1
  s_waitcnt vmcnt(0)
  s_branch L_qp_chk
L_qp_ok:
  s_mov_b64 exec, -1
  s_branch L_qok
L_qok3:
  s_mov_b32 s58, 1
  s_branch L_qok
L_qok2:
  buffer_load_dwordx4 a[96:99], v2, s[32:35], s53 offen offset:0 nt
  buffer_load_dwordx4 a[100:103], v2, s[32:35], s53 offen offset:1024 nt
  buffer_load_dwordx4 a[104:107], v2, s[32:35], s53 offen offset:2048 nt
  buffer_load_dwordx4 a[108:111], v2, s[32:35], s53 offen offset:3072 nt
  buffer_load_dwordx4 a[112:115], v3, s[36:39], s53 offen offset:0 nt
  buffer_load_dwordx4 a[116:119], v3, s[36:39], s53 offen offset:1024 nt
  buffer_load_dwordx4 a[120:123], v3, s[36:39], s53 offen offset:2048 nt
  buffer_load_dwordx4 a[124:127], v3, s[36:39], s53 offen offset:3072 nt
  s_add_u32 s53, s53, s69
  s_add_u32 s55, s55, 1
  s_cmp_eq_u32 s55, 8
  s_cselect_b32 s53, s54, s53
  s_cselect_b32 s69, 0x10000, s69
  s_cselect_b32 s32, s16, s32
  s_cselect_b32 s33, s17, s33
  s_cselect_b32 s36, s18, s36
  s_cselect_b32 s37, s19, s37
  s_mov_b32 s58, 1
L_qok:
  v_and_b32 v84, s61, v84
  v_and_b32 v85, s61, v85
  v_and_b32 v86, s61, v86
  v_and_b32 v87, s61, v87
  v_and_b32 v88, s61, v88
  v_and_b32 v89, s61, v89
  v_and_b32 v90, s61, v90
  v_and_b32 v91, s61, v91
  v_and_b32 v92, s61, v92
  v_and_b32 v93, s61, v93
  v_and_b32 v94, s61, v94
  v_and_b32 v95, s61, v95
  v_and_b32 v96, s61, v96
  v_and_b32 v97, s61, v97
  v_and_b32 v98, s61, v98
  v_and_b32 v99, s61, v99
  s_lshl_b32 s62, s52, 12
  v_add_u32 v15, s62, v3
  ds_write_b128 v15, v[84:87] offset:25600
  ds_write_b128 v15, v[88:91] offset:26624
  ds_write_b128 v15, v[92:95] offset:27648
  ds_write_b128 v15, v[96:99] offset:28672
  s_waitcnt lgkmcnt(0)
  s_barrier
  ds_read_b128 v[68:71], v3 offset:25600
  ds_read_b128 v[72:75], v3 offset:26624
  ds_read_b128 v[76:79], v3 offset:29696
  ds_read_b128 v[80:83], v3 offset:30720
  ds_read_b128 v[84:87], v3 offset:33792
  ds_read_b128 v[88:91], v3 offset:34816
  ds_read_b128 v[92:95], v3 offset:37888
  ds_read_b128 v[96:99], v3 offset:38912
  s_waitcnt lgkmcnt(0)
  v_add_f32 v68, v68, v76
  v_add_f32 v84, v84, v92
  v_add_f32 v69, v69, v77
  v_add_f32 v85, v85, v93
  v_add_f32 v70, v70, v78
  v_add_f32 v86, v86, v94
  v_add_f32 v71, v71, v79
  v_add_f32 v87, v87, v95
  v_add_f32 v72, v72, v80
  v_add_f32 v88, v88, v96
  v_add_f32 v73, v73, v81
  v_add_f32 v89, v89, v97
  v_add_f32 v74, v74, v82
  v_add_f32 v90, v90, v98
  v_add_f32 v75, v75, v83
  v_add_f32 v91, v91, v99
  v_add_f32 v68, v68, v84
  v_add_f32 v69, v69, v85
  v_add_f32 v70, v70, v86
  v_add_f32 v71, v71, v87
  v_add_f32 v72, v72, v88
  v_add_f32 v73, v73, v89
  v_add_f32 v74, v74, v90
  v_add_f32 v75, v75, v91
  v_cvt_pk_bf16_f32 v20, v68, v69
  v_cvt_pk_bf16_f32 v21, v70, v71
  v_cvt_pk_bf16_f32 v22, v72, v73
  v_cvt_pk_bf16_f32 v23, v74, v75
  s_mov_b32 s57, 0
  s_mov_b32 s31, 0
  s_mov_b32 s10, 0
  s_mov_b32 s75, -1
.p2align 3
L_round:
  s_cmp_lt_u32 s57, s56
  s_cbranch_scc1 L_nowait0
  s_sub_u32 s62, s55, s57
  s_cmp_eq_u32 s62, 1
  s_cbranch_scc0 L_wait0
  s_waitcnt vmcnt(0)
L_nowait0:
  s_add_u32 s62, s57, 1
  s_add_u32 s57, s57, 1
  s_cmp_eq_u32 s55, s62
  s_cbranch_scc0 L_noiss0
  s_cmp_ge_u32 s55, 31
  s_cbranch_scc1 L_dyn0
L_loads0:
  buffer_load_dwordx4 a[32:35], v2, s[32:35], s53 offen offset:0 nt
  buffer_load_dwordx4 a[36:39], v2, s[32:35], s53 offen offset:1024 nt
  buffer_load_dwordx4 a[40:43], v2, s[32:35], s53 offen offset:2048 nt
  buffer_load_dwordx4 a[44:47], v2, s[32:35], s53 offen offset:3072 nt
  buffer_load_dwordx4 a[48:51], v3, s[36:39], s53 offen offset:0 nt
  buffer_load_dwordx4 a[52:55], v3, s[36:39], s53 offen offset:1024 nt
  buffer_load_dwordx4 a[56:59], v3, s[36:39], s53 offen offset:2048 nt
  buffer_load_dwordx4 a[60:63], v3, s[36:39], s53 offen offset:3072 nt
  s_add_u32 s53, s53, s69
  s_add_u32 s55, s55, 1
  s_cmp_eq_u32 s55, 8
  s_cselect_b32 s53, s54, s53
  s_cselect_b32 s69, 0x10000, s69
  s_cselect_b32 s32, s16, s32
  s_cselect_b32 s33, s17, s33
  s_cselect_b32 s36, s18, s36
  s_cselect_b32 s37, s19, s37
L_noiss0:
  v_mfma_f32_16x16x32_bf16 v[52:55], a[0:3], v[20:23], 0
  v_mfma_f32_16x16x32_bf16 v[56:59], a[4:7], v[20:23], 0
  v_mfma_f32_16x16x32_bf16 v[60:63], a[8:11], v[20:23], 0
  v_mfma_f32_16x16x32_bf16 v[64:67], a[12:15], v[20:23], 0
  s_nop 4
  v_add_f32_dpp v15, v53, v52 row_ror:12 row_mask:0xf bank_mask:0xf
  v_add_f32_dpp v15, v54, v15 row_ror:8 row_mask:0xf bank_mask:0xf
  v_add_f32_dpp v11, v55, v15 row_ror:4 row_mask:0xf bank_mask:0x1
  v_add_f32_dpp v15, v58, v57 row_ror:12 row_mask:0xf bank_mask:0xf
  v_add_f32_dpp v15, v59, v15 row_ror:8 row_mask:0xf bank_mask:0xf
  v_add_f32_dpp v11, v56, v15 row_ror:4 row_mask:0xf bank_mask:0x2
  v_add_f32_dpp v15, v63, v62 row_ror:12 row_mask:0xf bank_mask:0xf
  v_add_f32_dpp v15, v60, v15 row_ror:8 row_mask:0xf bank_mask:0xf
  v_add_f32_dpp v11, v61, v15 row_ror:4 row_mask:0xf bank_mask:0x4
  v_add_f32_dpp v15, v64, v67 row_ror:12 row_mask:0xf bank_mask:0xf
  v_add_f32_dpp v15, v65, v15 row_ror:8 row_mask:0xf bank_mask:0xf
  v_add_f32_dpp v11, v66, v15 row_ror:4 row_mask:0xf bank_mask:0x8
  v_cmp_gt_f32 vcc, v11, v6
  s_cbranch_vccnz L_rare0
L_cont0:
  v_fma_f32 v12, v11, s59, -v7
  v_exp_f32 v12, v12
  s_nop 0
  v_cvt_pk_bf16_f32 v13, v12, 0
  v_cvt_pk_bf16_f32 v14, 0, v12
  v_add_f32 v8, v8, v12
  s_nop 0
  v_mov_b32_dpp v44, v13 quad_perm:[0,1,2,3] row_mask:0xf bank_mask:0x1
  v_mov_b32_dpp v44, v14 row_ror:4 row_mask:0xf bank_mask:0x2
  v_mov_b32_dpp v45, v13 row_ror:8 row_mask:0xf bank_mask:0x4
  v_mov_b32_dpp v45, v14 row_ror:12 row_mask:0xf bank_mask:0x8
  v_mov_b32_dpp v46, v13 row_ror:12 row_mask:0xf bank_mask:0x1
  v_mov_b32_dpp v46, v14 quad_perm:[0,1,2,3] row_mask:0xf bank_mask:0x2
  v_mov_b32_dpp v47, v13 row_ror:4 row_mask:0xf bank_mask:0x4
  v_mov_b32_dpp v47, v14 row_ror:8 row_mask:0xf bank_mask:0x8
  v_mov_b32_dpp v48, v13 row_ror:8 row_mask:0xf bank_mask:0x1
  v_mov_b32_dpp v48, v14 row_ror:12 row_mask:0xf bank_mask:0x2
  v_mov_b32_dpp v49, v13 quad_perm:[0,1,2,3] row_mask:0xf bank_mask:0x4
  v_mov_b32_dpp v49, v14 row_ror:4 row_mask:0xf bank_mask:0x8
  v_mov_b32_dpp v50, v13 row_ror:4 row_mask:0xf bank_mask:0x1
  v_mov_b32_dpp v50, v14 row_ror:8 row_mask:0xf bank_mask:0x2
  v_mov_b32_dpp v51, v13 row_ror:12 row_mask:0xf bank_mask:0x4
  v_mov_b32_dpp v51, v14 quad_perm:[0,1,2,3] row_mask:0xf bank_mask:0x8
  v_mfma_f32_16x16x16_bf16 v[28:31], a[16:17], v[44:45], v[28:31]
  v_mfma_f32_16x16x16_bf16 v[32:35], a[18:19], v[44:45], v[32:35]
  v_mfma_f32_16x16x16_bf16 v[28:31], a[20:21], v[46:47], v[28:31]
  v_mfma_f32_16x16x16_bf16 v[32:35], a[22:23], v[46:47], v[32:35]
  v_mfma_f32_16x16x16_bf16 v[28:31], a[24:25], v[48:49], v[28:31]
  v_mfma_f32_16x16x16_bf16 v[32:35], a[26:27], v[48:49], v[32:35]
  v_mfma_f32_16x16x16_bf16 v[28:31], a[28:29], v[50:51], v[28:31]
  v_mfma_f32_16x16x16_bf16 v[32:35], a[30:31], v[50:51], v[32:35]
  s_cmp_eq_u32 s57, s75
  s_cbranch_scc1 L_exit
  s_cmp_lt_u32 s57, s56
  s_cbranch_scc1 L_nowait1
  s_sub_u32 s62, s55, s57
  s_cmp_eq_u32 s62, 1
  s_cbranch_scc0 L_wait1
  s_waitcnt vmcnt(0)
L_nowait1:
  s_add_u32 s62, s57, 1
  s_add_u32 s57, s57, 1
  s_cmp_eq_u32 s58, 1
  s_cbranch_scc1 L_late1
  s_cmp_eq_u32 s55, s62
  s_cbranch_scc0 L_noiss1
  s_cmp_ge_u32 s55, 31
  s_cbranch_scc1 L_dyn1
L_loads1:
  buffer_load_dwordx4 a[64:67], v2, s[32:35], s53 offen offset:0 nt
  buffer_load_dwordx4 a[68:71], v2, s[32:35], s53 offen offset:1024 nt
  buffer_load_dwordx4 a[72:75], v2, s[32:35], s53 offen offset:2048 nt
  buffer_load_dwordx4 a[76:79], v2, s[32:35], s53 offen offset:3072 nt
  buffer_load_dwordx4 a[80:83], v3, s[36:39], s53 offen offset:0 nt
  buffer_load_dwordx4 a[84:87], v3, s[36:39], s53 offen offset:1024 nt
  buffer_load_dwordx4 a[88:91], v3, s[36:39], s53 offen offset:2048 nt
  buffer_load_dwordx4 a[92:95], v3, s[36:39], s53 offen offset:3072 nt
  s_add_u32 s53, s53, s69
  s_add_u32 s55, s55, 1
  s_cmp_eq_u32 s55, 8
  s_cselect_b32 s53, s54, s53
  s_cselect_b32 s69, 0x10000, s69
  s_cselect_b32 s32, s16, s32
  s_cselect_b32 s33, s17, s33
  s_cselect_b32 s36, s18, s36
  s_cselect_b32 s37, s19, s37
L_noiss1:
  v_mfma_f32_16x16x32_bf16 v[52:55], a[32:35], v[20:23], 0
  v_mfma_f32_16x16x32_bf16 v[56:59], a[36:39], v[20:23], 0
  v_mfma_f32_16x16x32_bf16 v[60:63], a[40:43], v[20:23], 0
  v_mfma_f32_16x16x32_bf16 v[64:67], a[44:47], v[20:23], 0
  s_nop 4
  v_add_f32_dpp v15, v53, v52 row_ror:12 row_mask:0xf bank_mask:0xf
  v_add_f32_dpp v15, v54, v15 row_ror:8 row_mask:0xf bank_mask:0xf
  v_add_f32_dpp v11, v55, v15 row_ror:4 row_mask:0xf bank_mask:0x1
  v_add_f32_dpp v15, v58, v57 row_ror:12 row_mask:0xf bank_mask:0xf
  v_add_f32_dpp v15, v59, v15 row_ror:8 row_mask:0xf bank_mask:0xf
  v_add_f32_dpp v11, v56, v15 row_ror:4 row_mask:0xf bank_mask:0x2
  v_add_f32_dpp v15, v63, v62 row_ror:12 row_mask:0xf bank_mask:0xf
  v_add_f32_dpp v15, v60, v15 row_ror:8 row_mask:0xf bank_mask:0xf
  v_add_f32_dpp v11, v61, v15 row_ror:4 row_mask:0xf bank_mask:0x4
  v_add_f32_dpp v15, v64, v67 row_ror:12 row_mask:0xf bank_mask:0xf
  v_add_f32_dpp v15, v65, v15 row_ror:8 row_mask:0xf bank_mask:0xf
  v_add_f32_dpp v11, v66, v15 row_ror:4 row_mask:0xf bank_mask:0x8
  v_cmp_gt_f32 vcc, v11, v6
  s_cbranch_vccnz L_rare1
L_cont1:
  v_fma_f32 v12, v11, s59, -v7
  v_exp_f32 v12, v12
  s_nop 0
  v_cvt_pk_bf16_f32 v13, v12, 0
  v_cvt_pk_bf16_f32 v14, 0, v12
  v_add_f32 v8, v8, v12
  s_nop 0
  v_mov_b32_dpp v44, v13 quad_perm:[0,1,2,3] row_mask:0xf bank_mask:0x1
  v_mov_b32_dpp v44, v14 row_ror:4 row_mask:0xf bank_mask:0x2
  v_mov_b32_dpp v45, v13 row_ror:8 row_mask:0xf bank_mask:0x4
  v_mov_b32_dpp v45, v14 row_ror:12 row_mask:0xf bank_mask:0x8
  v_mov_b32_dpp v46, v13 row_ror:12 row_mask:0xf bank_mask:0x1
  v_mov_b32_dpp v46, v14 quad_perm:[0,1,2,3] row_mask:0xf bank_mask:0x2
  v_mov_b32_dpp v47, v13 row_ror:4 row_mask:0xf bank_mask:0x4
  v_mov_b32_dpp v47, v14 row_ror:8 row_mask:0xf bank_mask:0x8
  v_mov_b32_dpp v48, v13 row_ror:8 row_mask:0xf bank_mask:0x1
  v_mov_b32_dpp v48, v14 row_ror:12 row_mask:0xf bank_mask:0x2
  v_mov_b32_dpp v49, v13 quad_perm:[0,1,2,3] row_mask:0xf bank_mask:0x4
  v_mov_b32_dpp v49, v14 row_ror:4 row_mask:0xf bank_mask:0x8
  v_mov_b32_dpp v50, v13 row_ror:4 row_mask:0xf bank_mask:0x1
  v_mov_b32_dpp v50, v14 row_ror:8 row_mask:0xf bank_mask:0x2
  v_mov_b32_dpp v51, v13 row_ror:12 row_mask:0xf bank_mask:0x4
  v_mov_b32_dpp v51, v14 quad_perm:[0,1,2,3] row_mask:0xf bank_mask:0x8
  v_mfma_f32_16x16x16_bf16 v[28:31], a[48:49], v[44:45], v[28:31]
  v_mfma_f32_16x16x16_bf16 v[32:35], a[50:51], v[44:45], v[32:35]
  v_mfma_f32_16x16x16_bf16 v[28:31], a[52:53], v[46:47], v[28:31]
  v_mfma_f32_16x16x16_bf16 v[32:35], a[54:55], v[46:47], v[32:35]
  v_mfma_f32_16x16x16_bf16 v[28:31], a[56:57], v[48:49], v[28:31]
  v_mfma_f32_16x16x16_bf16 v[32:35], a[58:59], v[48:49], v[32:35]
  v_mfma_f32_16x16x16_bf16 v[28:31], a[60:61], v[50:51], v[28:31]
  v_mfma_f32_16x16x16_bf16 v[32:35], a[62:63], v[50:51], v[32:35]
  s_cmp_eq_u32 s57, s75
  s_cbranch_scc1 L_exit
  s_cmp_lt_u32 s57, s56
  s_cbranch_scc1 L_nowait2
  s_sub_u32 s62, s55, s57
  s_cmp_eq_u32 s62, 1
  s_cbranch_scc0 L_wait2
  s_waitcnt vmcnt(0)
L_nowait2:
  s_add_u32 s62, s57, 1
  s_add_u32 s57, s57, 1
  s_cmp_eq_u32 s55, s62
  s_cbranch_scc0 L_noiss2
  s_cmp_ge_u32 s55, 31
  s_cbranch_scc1 L_dyn2
L_loads2:
  buffer_load_dwordx4 a[96:99], v2, s[32:35], s53 offen offset:0 nt
  buffer_load_dwordx4 a[100:103], v2, s[32:35], s53 offen offset:1024 nt
  buffer_load_dwordx4 a[104:107], v2, s[32:35], s53 offen offset:2048 nt
  buffer_load_dwordx4 a[108:111], v2, s[32:35], s53 offen offset:3072 nt
  buffer_load_dwordx4 a[112:115], v3, s[36:39], s53 offen offset:0 nt
  buffer_load_dwordx4 a[116:119], v3, s[36:39], s53 offen offset:1024 nt
  buffer_load_dwordx4 a[120:123], v3, s[36:39], s53 offen offset:2048 nt
  buffer_load_dwordx4 a[124:127], v3, s[36:39], s53 offen offset:3072 nt
  s_add_u32 s53, s53, s69
  s_add_u32 s55, s55, 1
  s_cmp_eq_u32 s55, 8
  s_cselect_b32 s53, s54, s53
  s_cselect_b32 s69, 0x10000, s69
  s_cselect_b32 s32, s16, s32
  s_cselect_b32 s33, s17, s33
  s_cselect_b32 s36, s18, s36
  s_cselect_b32 s37, s19, s37
L_noiss2:
  v_mfma_f32_16x16x32_bf16 v[52:55], a[64:67], v[20:23], 0
  v_mfma_f32_16x16x32_bf16 v[56:59], a[68:71], v[20:23], 0
  v_mfma_f32_16x16x32_bf16 v[60:63], a[72:75], v[20:23], 0
  v_mfma_f32_16x16x32_bf16 v[64:67], a[76:79], v[20:23], 0
  s_nop 4
  v_add_f32_dpp v15, v53, v52 row_ror:12 row_mask:0xf bank_mask:0xf
  v_add_f32_dpp v15, v54, v15 row_ror:8 row_mask:0xf bank_mask:0xf
  v_add_f32_dpp v11, v55, v15 row_ror:4 row_mask:0xf bank_mask:0x1
  v_add_f32_dpp v15, v58, v57 row_ror:12 row_mask:0xf bank_mask:0xf
  v_add_f32_dpp v15, v59, v15 row_ror:8 row_mask:0xf bank_mask:0xf
  v_add_f32_dpp v11, v56, v15 row_ror:4 row_mask:0xf bank_mask:0x2
  v_add_f32_dpp v15, v63, v62 row_ror:12 row_mask:0xf bank_mask:0xf
  v_add_f32_dpp v15, v60, v15 row_ror:8 row_mask:0xf bank_mask:0xf
  v_add_f32_dpp v11, v61, v15 row_ror:4 row_mask:0xf bank_mask:0x4
  v_add_f32_dpp v15, v64, v67 row_ror:12 row_mask:0xf bank_mask:0xf
  v_add_f32_dpp v15, v65, v15 row_ror:8 row_mask:0xf bank_mask:0xf
  v_add_f32_dpp v11, v66, v15 row_ror:4 row_mask:0xf bank_mask:0x8
  v_cmp_gt_f32 vcc, v11, v6
  s_cbranch_vccnz L_rare2
L_cont2:
  v_fma_f32 v12, v11, s59, -v7
  v_exp_f32 v12, v12
  s_nop 0
  v_cvt_pk_bf16_f32 v13, v12, 0
  v_cvt_pk_bf16_f32 v14, 0, v12
  v_add_f32 v8, v8, v12
  s_nop 0
  v_mov_b32_dpp v44, v13 quad_perm:[0,1,2,3] row_mask:0xf bank_mask:0x1
  v_mov_b32_dpp v44, v14 row_ror:4 row_mask:0xf bank_mask:0x2
  v_mov_b32_dpp v45, v13 row_ror:8 row_mask:0xf bank_mask:0x4
  v_mov_b32_dpp v45, v14 row_ror:12 row_mask:0xf bank_mask:0x8
  v_mov_b32_dpp v46, v13 row_ror:12 row_mask:0xf bank_mask:0x1
  v_mov_b32_dpp v46, v14 quad_perm:[0,1,2,3] row_mask:0xf bank_mask:0x2
  v_mov_b32_dpp v47, v13 row_ror:4 row_mask:0xf bank_mask:0x4
  v_mov_b32_dpp v47, v14 row_ror:8 row_mask:0xf bank_mask:0x8
  v_mov_b32_dpp v48, v13 row_ror:8 row_mask:0xf bank_mask:0x1
  v_mov_b32_dpp v48, v14 row_ror:12 row_mask:0xf bank_mask:0x2
  v_mov_b32_dpp v49, v13 quad_perm:[0,1,2,3] row_mask:0xf bank_mask:0x4
  v_mov_b32_dpp v49, v14 row_ror:4 row_mask:0xf bank_mask:0x8
  v_mov_b32_dpp v50, v13 row_ror:4 row_mask:0xf bank_mask:0x1
  v_mov_b32_dpp v50, v14 row_ror:8 row_mask:0xf bank_mask:0x2
  v_mov_b32_dpp v51, v13 row_ror:12 row_mask:0xf bank_mask:0x4
  v_mov_b32_dpp v51, v14 quad_perm:[0,1,2,3] row_mask:0xf bank_mask:0x8
  v_mfma_f32_16x16x16_bf16 v[28:31], a[80:81], v[44:45], v[28:31]
  v_mfma_f32_16x16x16_bf16 v[32:35], a[82:83], v[44:45], v[32:35]
  v_mfma_f32_16x16x16_bf16 v[28:31], a[84:85], v[46:47], v[28:31]
  v_mfma_f32_16x16x16_bf16 v[32:35], a[86:87], v[46:47], v[32:35]
  v_mfma_f32_16x16x16_bf16 v[28:31], a[88:89], v[48:49], v[28:31]
  v_mfma_f32_16x16x16_bf16 v[32:35], a[90:91], v[48:49], v[32:35]
  v_mfma_f32_16x16x16_bf16 v[28:31], a[92:93], v[50:51], v[28:31]
  v_mfma_f32_16x16x16_bf16 v[32:35], a[94:95], v[50:51], v[32:35]
  s_cmp_eq_u32 s57, s75
  s_cbranch_scc1 L_exit
  s_cmp_lt_u32 s57, s56
  s_cbranch_scc1 L_nowait3
  s_sub_u32 s62, s55, s57
  s_cmp_eq_u32 s62, 1
  s_cbranch_scc0 L_wait3
  s_waitcnt vmcnt(0)
L_nowait3:
  s_add_u32 s62, s57, 1
  s_add_u32 s57, s57, 1
  s_cmp_eq_u32 s55, s62
  s_cbranch_scc0 L_noiss3
  s_cmp_ge_u32 s55, 31
  s_cbranch_scc1 L_dyn3
L_loads3:
  buffer_load_dwordx4 a[0:3], v2, s[32:35], s53 offen offset:0 nt
  buffer_load_dwordx4 a[4:7], v2, s[32:35], s53 offen offset:1024 nt
  buffer_load_dwordx4 a[8:11], v2, s[32:35], s53 offen offset:2048 nt
  buffer_load_dwordx4 a[12:15], v2, s[32:35], s53 offen offset:3072 nt
  buffer_load_dwordx4 a[16:19], v3, s[36:39], s53 offen offset:0 nt
  buffer_load_dwordx4 a[20:23], v3, s[36:39], s53 offen offset:1024 nt
  buffer_load_dwordx4 a[24:27], v3, s[36:39], s53 offen offset:2048 nt
  buffer_load_dwordx4 a[28:31], v3, s[36:39], s53 offen offset:3072 nt
  s_add_u32 s53, s53, s69
  s_add_u32 s55, s55, 1
  s_cmp_eq_u32 s55, 8
  s_cselect_b32 s53, s54, s53
  s_cselect_b32 s69, 0x10000, s69
  s_cselect_b32 s32, s16, s32
  s_cselect_b32 s33, s17, s33
  s_cselect_b32 s36, s18, s36
  s_cselect_b32 s37, s19, s37
L_noiss3:
  v_mfma_f32_16x16x32_bf16 v[52:55], a[96:99], v[20:23], 0
  v_mfma_f32_16x16x32_bf16 v[56:59], a[100:103], v[20:23], 0
  v_mfma_f32_16x16x32_bf16 v[60:63], a[104:107], v[20:23], 0
  v_mfma_f32_16x16x32_bf16 v[64:67], a[108:111], v[20:23], 0
  s_nop 4
  v_add_f32_dpp v15, v53, v52 row_ror:12 row_mask:0xf bank_mask:0xf
  v_add_f32_dpp v15, v54, v15 row_ror:8 row_mask:0xf bank_mask:0xf
  v_add_f32_dpp v11, v55, v15 row_ror:4 row_mask:0xf bank_mask:0x1
  v_add_f32_dpp v15, v58, v57 row_ror:12 row_mask:0xf bank_mask:0xf
  v_add_f32_dpp v15, v59, v15 row_ror:8 row_mask:0xf bank_mask:0xf
  v_add_f32_dpp v11, v56, v15 row_ror:4 row_mask:0xf bank_mask:0x2
  v_add_f32_dpp v15, v63, v62 row_ror:12 row_mask:0xf bank_mask:0xf
  v_add_f32_dpp v15, v60, v15 row_ror:8 row_mask:0xf bank_mask:0xf
  v_add_f32_dpp v11, v61, v15 row_ror:4 row_mask:0xf bank_mask:0x4
  v_add_f32_dpp v15, v64, v67 row_ror:12 row_mask:0xf bank_mask:0xf
  v_add_f32_dpp v15, v65, v15 row_ror:8 row_mask:0xf bank_mask:0xf
  v_add_f32_dpp v11, v66, v15 row_ror:4 row_mask:0xf bank_mask:0x8
  v_cmp_gt_f32 vcc, v11, v6
  s_cbranch_vccnz L_rare3
L_cont3:
  v_fma_f32 v12, v11, s59, -v7
  v_exp_f32 v12, v12
  s_nop 0
  v_cvt_pk_bf16_f32 v13, v12, 0
  v_cvt_pk_bf16_f32 v14, 0, v12
  v_add_f32 v8, v8, v12
  s_nop 0
  v_mov_b32_dpp v44, v13 quad_perm:[0,1,2,3] row_mask:0xf bank_mask:0x1
  v_mov_b32_dpp v44, v14 row_ror:4 row_mask:0xf bank_mask:0x2
  v_mov_b32_dpp v45, v13 row_ror:8 row_mask:0xf bank_mask:0x4
  v_mov_b32_dpp v45, v14 row_ror:12 row_mask:0xf bank_mask:0x8
  v_mov_b32_dpp v46, v13 row_ror:12 row_mask:0xf bank_mask:0x1
  v_mov_b32_dpp v46, v14 quad_perm:[0,1,2,3] row_mask:0xf bank_mask:0x2
  v_mov_b32_dpp v47, v13 row_ror:4 row_mask:0xf bank_mask:0x4
  v_mov_b32_dpp v47, v14 row_ror:8 row_mask:0xf bank_mask:0x8
  v_mov_b32_dpp v48, v13 row_ror:8 row_mask:0xf bank_mask:0x1
  v_mov_b32_dpp v48, v14 row_ror:12 row_mask:0xf bank_mask:0x2
  v_mov_b32_dpp v49, v13 quad_perm:[0,1,2,3] row_mask:0xf bank_mask:0x4
  v_mov_b32_dpp v49, v14 row_ror:4 row_mask:0xf bank_mask:0x8
  v_mov_b32_dpp v50, v13 row_ror:4 row_mask:0xf bank_mask:0x1
  v_mov_b32_dpp v50, v14 row_ror:8 row_mask:0xf bank_mask:0x2
  v_mov_b32_dpp v51, v13 row_ror:12 row_mask:0xf bank_mask:0x4
  v_mov_b32_dpp v51, v14 quad_perm:[0,1,2,3] row_mask:0xf bank_mask:0x8
  v_mfma_f32_16x16x16_bf16 v[28:31], a[112:113], v[44:45], v[28:31]
  v_mfma_f32_16x16x16_bf16 v[32:35], a[114:115], v[44:45], v[32:35]
  v_mfma_f32_16x16x16_bf16 v[28:31], a[116:117], v[46:47], v[28:31]
  v_mfma_f32_16x16x16_bf16 v[32:35], a[118:119], v[46:47], v[32:35]
  v_mfma_f32_16x16x16_bf16 v[28:31], a[120:121], v[48:49], v[28:31]
  v_mfma_f32_16x16x16_bf16 v[32:35], a[122:123], v[48:49], v[32:35]
  v_mfma_f32_16x16x16_bf16 v[28:31], a[124:125], v[50:51], v[28:31]
  v_mfma_f32_16x16x16_bf16 v[32:35], a[126:127], v[50:51], v[32:35]
  s_cmp_eq_u32 s57, s75
  s_cbranch_scc1 L_exit
  s_mov_b32 s58, 0
  s_cmp_eq_u32 s57, 8
  s_cbranch_scc0 L_round
  s_add_u32 s66, s57, 1
  s_cmp_eq_u32 s55, s66
  s_cbranch_scc0 L_ah0
  buffer_load_dwordx4 a[32:35], v2, s[32:35], s53 offen offset:0 nt
  buffer_load_dwordx4 a[36:39], v2, s[32:35], s53 offen offset:1024 nt
  buffer_load_dwordx4 a[40:43], v2, s[32:35], s53 offen offset:2048 nt
  buffer_load_dwordx4 a[44:47], v2, s[32:35], s53 offen offset:3072 nt
  buffer_load_dwordx4 a[48:51], v3, s[36:39], s53 offen offset:0 nt
  buffer_load_dwordx4 a[52:55], v3, s[36:39], s53 offen offset:1024 nt
  buffer_load_dwordx4 a[56:59], v3, s[36:39], s53 offen offset:2048 nt
  buffer_load_dwordx4 a[60:63], v3, s[36:39], s53 offen offset:3072 nt
  s_add_u32 s53, s53, s69
  s_add_u32 s55, s55, 1
  s_cmp_eq_u32 s55, 8
  s_cselect_b32 s53, s54, s53
  s_cselect_b32 s69, 0x10000, s69
  s_cselect_b32 s32, s16, s32
  s_cselect_b32 s33, s17, s33
  s_cselect_b32 s36, s18, s36
  s_cselect_b32 s37, s19, s37
L_ah0:
  s_nop 7
  s_nop 1
  v_add_f32_dpp v8, v8, v8 row_ror:4 row_mask:0xf bank_mask:0xf
  s_nop 1
  v_add_f32_dpp v8, v8, v8 row_ror:8 row_mask:0xf bank_mask:0xf
  v_mov_b32 v16, v8
  s_nop 1
  v_permlane16_swap_b32 v8, v16
  s_nop 1
  v_add_f32 v8, v8, v16
  v_mov_b32 v16, v8
  s_nop 1
  v_permlane32_swap_b32 v8, v16
  s_nop 1
  v_add_f32 v8, v8, v16
  s_mul_i32 s62, s52, 3136
  v_add_u32 v15, s62, v4
  ds_write_b32 v15, v28 offset:0
  ds_write_b32 v15, v29 offset:32
  ds_write_b32 v15, v30 offset:64
  ds_write_b32 v15, v31 offset:96
  ds_write_b32 v15, v32 offset:16
  ds_write_b32 v15, v33 offset:48
  ds_write_b32 v15, v34 offset:80
  ds_write_b32 v15, v35 offset:112
  s_lshl_b32 s62, s52, 5
  v_lshl_add_u32 v15, v1, 3, s62
  v_mov_b32 v68, v6
  v_mov_b32 v69, v8
  s_mov_b64 exec, 0xf
  ds_write_b64 v15, v[68:69] offset:12544
  s_mov_b64 exec, -1
  s_waitcnt lgkmcnt(0)
  v_mov_b32 v15, 1
  s_mov_b64 exec, 1
  ds_add_rtn_u32 v15, v19, v15 offset:50688
  s_mov_b64 exec, -1
  s_waitcnt lgkmcnt(0)
  v_readfirstlane_b32 s62, v15
  s_nop 1
  s_cmp_lg_u32 s62, 3
  s_cbranch_scc1 L_pubA_done
  v_lshrrev_b32 v108, 5, v1
  v_mul_u32_u24 v108, 196, v108
  v_bfe_u32 v15, v1, 3, 2
  v_mad_u32_u24 v108, v15, 48, v108
  v_and_b32 v15, 7, v1
  v_lshl_add_u32 v108, v15, 2, v108
  v_lshlrev_b32 v108, 2, v108
  v_lshrrev_b32 v70, 5, v1
  v_lshlrev_b32 v72, 3, v70
  ds_read_b64 v[92:93], v72 offset:12544
  ds_read_b64 v[94:95], v72 offset:12576
  ds_read_b64 v[96:97], v72 offset:12608
  ds_read_b64 v[98:99], v72 offset:12640
  ds_read_b128 v[76:79], v108 offset:0
  ds_read_b128 v[80:83], v108 offset:3136
  ds_read_b128 v[84:87], v108 offset:6272
  ds_read_b128 v[88:91], v108 offset:9408
  s_lshl_b32 s62, s71, 3
  s_add_u32 s62, s62, s70
  s_lshl_b32 s62, s62, 2
  s_add_u32 s62, s62, s30
  s_lshl_b32 s63, s62, 5
  s_add_u32 s63, s63, 2162688
  s_lshl_b32 s62, s62, 11
  s_add_u32 s62, s62, 1114112
  v_lshlrev_b32 v71, 9, v70
  v_and_b32 v15, 31, v1
  v_lshl_add_u32 v71, v15, 4, v71
  s_waitcnt lgkmcnt(4)
  v_max_f32 v100, v92, v94
  v_max3_f32 v100, v100, v96, v98
  v_sub_f32 v92, v92, v100
  v_sub_f32 v94, v94, v100
  v_sub_f32 v96, v96, v100
  v_sub_f32 v98, v98, v100
  v_mul_f32 v92, s59, v92
  v_mul_f32 v94, s59, v94
  v_mul_f32 v96, s59, v96
  v_mul_f32 v98, s59, v98
  v_exp_f32 v92, v92
  v_exp_f32 v94, v94
  v_exp_f32 v96, v96
  v_exp_f32 v98, v98
  v_mul_f32 v101, v92, v93
  v_fmac_f32 v101, v94, v95
  v_fmac_f32 v101, v96, v97
  v_fmac_f32 v101, v98, v99
  v_rcp_f32 v93, v101
  v_log_f32 v101, v101
  s_nop 0
  v_mul_f32 v92, v92, v93
  v_mul_f32 v94, v94, v93
  v_mul_f32 v96, v96, v93
  v_mul_f32 v98, v98, v93
  v_fma_f32 v100, v100, s59, v101
  s_waitcnt lgkmcnt(0)
  v_mul_f32 v76, v92, v76
  v_mul_f32 v77, v92, v77
  v_mul_f32 v78, v92, v78
  v_mul_f32 v79, v92, v79
  v_fmac_f32 v76, v94, v80
  v_fmac_f32 v77, v94, v81
  v_fmac_f32 v78, v94, v82
  v_fmac_f32 v79, v94, v83
  v_fmac_f32 v76, v96, v84
  v_fmac_f32 v77, v96, v85
  v_fmac_f32 v78, v96, v86
  v_fmac_f32 v79, v96, v87
  v_fmac_f32 v76, v98, v88
  v_fmac_f32 v77, v98, v89
  v_fmac_f32 v78, v98, v90
  v_fmac_f32 v79, v98, v91
  v_bfi_b32 v76, s60, v5, v76
  v_bfi_b32 v77, s60, v5, v77
  v_bfi_b32 v78, s60, v5, v78
  v_bfi_b32 v79, s60, v5, v79
  buffer_store_dwordx4 v[76:79], v71, s[40:43], s62 offen sc1
  v_bfi_b32 v100, s60, v5, v100
  v_mov_b32 v101, v5
  v_cmp_eq_u32 vcc, 0, v15
  s_and_saveexec_b64 s[64:65], vcc
  buffer_store_dwordx2 v[100:101], v72, s[40:43], s63 offen sc1
  s_mov_b64 exec, -1
  s_nop 0
  v_lshrrev_b32 v70, 5, v1
  v_add_u32 v70, 2, v70
  v_lshlrev_b32 v72, 3, v70
  ds_read_b64 v[92:93], v72 offset:12544
  ds_read_b64 v[94:95], v72 offset:12576
  ds_read_b64 v[96:97], v72 offset:12608
  ds_read_b64 v[98:99], v72 offset:12640
  ds_read_b128 v[76:79], v108 offset:1568
  ds_read_b128 v[80:83], v108 offset:4704
  ds_read_b128 v[84:87], v108 offset:7840
  ds_read_b128 v[88:91], v108 offset:10976
  s_lshl_b32 s62, s71, 3
  s_add_u32 s62, s62, s70
  s_lshl_b32 s62, s62, 2
  s_add_u32 s62, s62, s30
  s_lshl_b32 s63, s62, 5
  s_add_u32 s63, s63, 2162688
  s_lshl_b32 s62, s62, 11
  s_add_u32 s62, s62, 1114112
  v_lshlrev_b32 v71, 9, v70
  v_and_b32 v15, 31, v1
  v_lshl_add_u32 v71, v15, 4, v71
  s_waitcnt lgkmcnt(4)
  v_max_f32 v100, v92, v94
  v_max3_f32 v100, v100, v96, v98
  v_sub_f32 v92, v92, v100
  v_sub_f32 v94, v94, v100
  v_sub_f32 v96, v96, v100
  v_sub_f32 v98, v98, v100
  v_mul_f32 v92, s59, v92
  v_mul_f32 v94, s59, v94
  v_mul_f32 v96, s59, v96
  v_mul_f32 v98, s59, v98
  v_exp_f32 v92, v92
  v_exp_f32 v94, v94
  v_exp_f32 v96, v96
  v_exp_f32 v98, v98
  v_mul_f32 v101, v92, v93
  v_fmac_f32 v101, v94, v95
  v_fmac_f32 v101, v96, v97
  v_fmac_f32 v101, v98, v99
  v_rcp_f32 v93, v101
  v_log_f32 v101, v101
  s_nop 0
  v_mul_f32 v92, v92, v93
  v_mul_f32 v94, v94, v93
  v_mul_f32 v96, v96, v93
  v_mul_f32 v98, v98, v93
  v_fma_f32 v100, v100, s59, v101
  s_waitcnt lgkmcnt(0)
  v_mul_f32 v76, v92, v76
  v_mul_f32 v77, v92, v77
  v_mul_f32 v78, v92, v78
  v_mul_f32 v79, v92, v79
  v_fmac_f32 v76, v94, v80
  v_fmac_f32 v77, v94, v81
  v_fmac_f32 v78, v94, v82
  v_fmac_f32 v79, v94, v83
  v_fmac_f32 v76, v96, v84
  v_fmac_f32 v77, v96, v85
  v_fmac_f32 v78, v96, v86
  v_fmac_f32 v79, v96, v87
  v_fmac_f32 v76, v98, v88
  v_fmac_f32 v77, v98, v89
  v_fmac_f32 v78, v98, v90
  v_fmac_f32 v79, v98, v91
  v_bfi_b32 v76, s60, v5, v76
  v_bfi_b32 v77, s60, v5, v77
  v_bfi_b32 v78, s60, v5, v78
  v_bfi_b32 v79, s60, v5, v79
  buffer_store_dwordx4 v[76:79], v71, s[40:43], s62 offen sc1
  v_bfi_b32 v100, s60, v5, v100
  v_mov_b32 v101, v5
  v_cmp_eq_u32 vcc, 0, v15
  s_and_saveexec_b64 s[64:65], vcc
  buffer_store_dwordx2 v[100:101], v72, s[40:43], s63 offen sc1
  s_mov_b64 exec, -1
L_pubA_done:
  v_mov_b32 v28, 0
  v_mov_b32 v29, 0
  v_mov_b32 v30, 0
  v_mov_b32 v31, 0
  v_mov_b32 v32, 0
  v_mov_b32 v33, 0
  v_mov_b32 v34, 0
  v_mov_b32 v35, 0
  v_mov_b32 v6, 0xff800000
  v_mov_b32 v7, 0xff800000
  v_mov_b32 v8, 0
  ds_read_b128 v[68:71], v3 offset:27648
  ds_read_b128 v[72:75], v3 offset:28672
  ds_read_b128 v[76:79], v3 offset:31744
  ds_read_b128 v[80:83], v3 offset:32768
  ds_read_b128 v[84:87], v3 offset:35840
  ds_read_b128 v[88:91], v3 offset:36864
  ds_read_b128 v[92:95], v3 offset:39936
  ds_read_b128 v[96:99], v3 offset:40960
  s_waitcnt lgkmcnt(0)
  v_add_f32 v68, v68, v76
  v_add_f32 v84, v84, v92
  v_add_f32 v69, v69, v77
  v_add_f32 v85, v85, v93
  v_add_f32 v70, v70, v78
  v_add_f32 v86, v86, v94
  v_add_f32 v71, v71, v79
  v_add_f32 v87, v87, v95
  v_add_f32 v72, v72, v80
  v_add_f32 v88, v88, v96
  v_add_f32 v73, v73, v81
  v_add_f32 v89, v89, v97
  v_add_f32 v74, v74, v82
  v_add_f32 v90, v90, v98
  v_add_f32 v75, v75, v83
  v_add_f32 v91, v91, v99
  v_add_f32 v68, v68, v84
  v_add_f32 v69, v69, v85
  v_add_f32 v70, v70, v86
  v_add_f32 v71, v71, v87
  v_add_f32 v72, v72, v88
  v_add_f32 v73, v73, v89
  v_add_f32 v74, v74, v90
  v_add_f32 v75, v75, v91
  v_cvt_pk_bf16_f32 v20, v68, v69
  v_cvt_pk_bf16_f32 v21, v70, v71
  v_cvt_pk_bf16_f32 v22, v72, v73
  v_cvt_pk_bf16_f32 v23, v74, v75
  s_nop 1
  s_branch L_round
L_exit:
  s_nop 7
  s_nop 1
  v_add_f32_dpp v8, v8, v8 row_ror:4 row_mask:0xf bank_mask:0xf
  s_nop 1
  v_add_f32_dpp v8, v8, v8 row_ror:8 row_mask:0xf bank_mask:0xf
  v_mov_b32 v16, v8
  s_nop 1
  v_permlane16_swap_b32 v8, v16
  s_nop 1
  v_add_f32 v8, v8, v16
  v_mov_b32 v16, v8
  s_nop 1
  v_permlane32_swap_b32 v8, v16
  s_nop 1
  v_add_f32 v8, v8, v16
  s_mul_i32 s62, s52, 3136
  v_add_u32 v15, s62, v4
  ds_write_b32 v15, v28 offset:12800
  ds_write_b32 v15, v29 offset:12832
  ds_write_b32 v15, v30 offset:12864
  ds_write_b32 v15, v31 offset:12896
  ds_write_b32 v15, v32 offset:12816
  ds_write_b32 v15, v33 offset:12848
  ds_write_b32 v15, v34 offset:12880
  ds_write_b32 v15, v35 offset:12912
  s_lshl_b32 s62, s52, 5
  v_lshl_add_u32 v15, v1, 3, s62
  v_mov_b32 v68, v6
  v_mov_b32 v69, v8
  s_mov_b64 exec, 0xf
  ds_write_b64 v15, v[68:69] offset:25344
  s_mov_b64 exec, -1
  s_waitcnt lgkmcnt(0)
  s_barrier
  s_cmp_ge_u32 s52, 2
  s_cbranch_scc1 L_pubB_done
  v_mov_b32 v16, 1
  v_lshlrev_b32 v15, 8, v1
  s_mov_b64 exec, 0xff
  buffer_atomic_add v16, v15, s[40:43], s20 offen sc1
  s_mov_b64 exec, -1
  v_lshrrev_b32 v70, 5, v0
  v_lshlrev_b32 v72, 3, v70
  ds_read_b64 v[92:93], v72 offset:25344
  ds_read_b64 v[94:95], v72 offset:25376
  ds_read_b64 v[96:97], v72 offset:25408
  ds_read_b64 v[98:99], v72 offset:25440
  ds_read_b128 v[76:79], v9 offset:12800
  ds_read_b128 v[80:83], v9 offset:15936
  ds_read_b128 v[84:87], v9 offset:19072
  ds_read_b128 v[88:91], v9 offset:22208
  s_lshl_b32 s62, s71, 3
  s_add_u32 s62, s62, s70
  s_lshl_b32 s62, s62, 2
  s_add_u32 s62, s62, s30
  s_lshl_b32 s63, s62, 5
  s_add_u32 s63, s63, 2170880
  s_lshl_b32 s62, s62, 11
  s_add_u32 s62, s62, 1638400
  v_lshlrev_b32 v71, 9, v70
  v_and_b32 v15, 31, v0
  v_lshl_add_u32 v71, v15, 4, v71
  s_waitcnt lgkmcnt(4)
  v_max_f32 v100, v92, v94
  v_max3_f32 v100, v100, v96, v98
  v_sub_f32 v92, v92, v100
  v_sub_f32 v94, v94, v100
  v_sub_f32 v96, v96, v100
  v_sub_f32 v98, v98, v100
  v_mul_f32 v92, s59, v92
  v_mul_f32 v94, s59, v94
  v_mul_f32 v96, s59, v96
  v_mul_f32 v98, s59, v98
  v_exp_f32 v92, v92
  v_exp_f32 v94, v94
  v_exp_f32 v96, v96
  v_exp_f32 v98, v98
  v_mul_f32 v101, v92, v93
  v_fmac_f32 v101, v94, v95
  v_fmac_f32 v101, v96, v97
  v_fmac_f32 v101, v98, v99
  v_rcp_f32 v93, v101
  v_log_f32 v101, v101
  s_nop 0
  v_mul_f32 v92, v92, v93
  v_mul_f32 v94, v94, v93
  v_mul_f32 v96, v96, v93
  v_mul_f32 v98, v98, v93
  v_fma_f32 v100, v100, s59, v101
  s_waitcnt lgkmcnt(0)
  v_mul_f32 v76, v92, v76
  v_mul_f32 v77, v92, v77
  v_mul_f32 v78, v92, v78
  v_mul_f32 v79, v92, v79
  v_fmac_f32 v76, v94, v80
  v_fmac_f32 v77, v94, v81
  v_fmac_f32 v78, v94, v82
  v_fmac_f32 v79, v94, v83
  v_fmac_f32 v76, v96, v84
  v_fmac_f32 v77, v96, v85
  v_fmac_f32 v78, v96, v86
  v_fmac_f32 v79, v96, v87
  v_fmac_f32 v76, v98, v88
  v_fmac_f32 v77, v98, v89
  v_fmac_f32 v78, v98, v90
  v_fmac_f32 v79, v98, v91
  v_bfi_b32 v76, s60, v5, v76
  v_bfi_b32 v77, s60, v5, v77
  v_bfi_b32 v78, s60, v5, v78
  v_bfi_b32 v79, s60, v5, v79
  buffer_store_dwordx4 v[76:79], v71, s[40:43], s62 offen sc1
  v_bfi_b32 v100, s60, v5, v100
  v_mov_b32 v101, v5
  v_cmp_eq_u32 vcc, 0, v15
  s_and_saveexec_b64 s[64:65], vcc
  buffer_store_dwordx2 v[100:101], v72, s[40:43], s63 offen sc1
  s_mov_b64 exec, -1
L_pubB_done:
  buffer_load_dwordx4 a[0:3], v39, s[48:51], s26 offen offset:0 nt
  buffer_load_dwordx4 a[4:7], v39, s[48:51], s26 offen offset:1024 nt
  buffer_load_dwordx4 a[8:11], v39, s[48:51], s26 offen offset:2048 nt
  buffer_load_dwordx4 a[12:15], v39, s[48:51], s26 offen offset:3072 nt
  s_cmp_ge_u32 s52, 2
  s_cbranch_scc1 L_wA4
  s_waitcnt vmcnt(7)
  s_branch L_wAd
L_wA4:
  s_waitcnt vmcnt(4)
L_wAd:
  s_mov_b32 s68, 0x40000
L_h10_chk:
  v_xor_b32 v15, v108, v5
  v_bitop3_b32 v15, v15, v109, v5 bitop3:0xf6
  v_bitop3_b32 v15, v15, v110, v5 bitop3:0xf6
  v_bitop3_b32 v15, v15, v111, v5 bitop3:0xf6
  v_bitop3_b32 v15, v15, v40, v5 bitop3:0xf6
  v_bitop3_b32 v15, v15, v41, v5 bitop3:0xf6
  v_bitop3_b32 v15, v15, v42, v5 bitop3:0xf6
  v_bitop3_b32 v15, v15, v43, v5 bitop3:0xf6
  v_bitop3_b32 v15, v15, v24, v5 bitop3:0xf6
  v_bitop3_b32 v15, v15, v26, v5 bitop3:0xf6
  v_and_b32 v15, 0xff, v15
  v_bitop3_b32 v15, v15, v25, v5 bitop3:0xf6
  v_bitop3_b32 v15, v15, v27, v5 bitop3:0xf6
  v_cmp_ne_u32 vcc, 0, v15
  s_cbranch_vccz L_h10_ok
  s_sub_u32 s68, s68, 1
  s_cmp_eq_u32 s68, 0
  s_cbranch_scc1 L_h10_ok
  s_mov_b64 exec, vcc
  s_add_u32 s66, s97, 0
  s_add_u32 s67, s97, 32768
  s_add_u32 s27, s98, 0
  buffer_load_dwordx2 v[24:25], v37, s[40:43], s27 offen sc1
  buffer_load_dwordx2 v[26:27], v37, s[40:43], s27 offen offset:512 sc1
  buffer_load_dwordx4 v[108:111], v36, s[40:43], s66 offen sc1
  buffer_load_dwordx4 v[40:43], v36, s[40:43], s67 offen sc1
  s_waitcnt vmcnt(0)
  s_branch L_h10_chk
L_h10_ok:
  s_mov_b64 exec, -1
  v_and_b32 v24, s61, v24
  v_and_b32 v26, s61, v26
  v_and_b32 v108, s61, v108
  v_and_b32 v109, s61, v109
  v_and_b32 v110, s61, v110
  v_and_b32 v111, s61, v111
  v_and_b32 v40, s61, v40
  v_and_b32 v41, s61, v41
  v_and_b32 v42, s61, v42
  v_and_b32 v43, s61, v43
  v_max_f32_dpp v15, v24, v24 row_ror:4 row_mask:0xf bank_mask:0xf
  v_max_f32_dpp v16, v26, v26 row_ror:4 row_mask:0xf bank_mask:0xf
  s_nop 0
  v_max_f32_dpp v15, v15, v15 row_ror:8 row_mask:0xf bank_mask:0xf
  v_max_f32_dpp v16, v16, v16 row_ror:8 row_mask:0xf bank_mask:0xf
  v_sub_f32 v24, v24, v15
  v_sub_f32 v26, v26, v16
  v_exp_f32 v24, v24
  v_exp_f32 v26, v26
  s_nop 1
  v_add_f32_dpp v25, v24, v24 row_ror:4 row_mask:0xf bank_mask:0xf
  v_add_f32_dpp v27, v26, v26 row_ror:4 row_mask:0xf bank_mask:0xf
  s_nop 0
  v_add_f32_dpp v25, v25, v25 row_ror:8 row_mask:0xf bank_mask:0xf
  v_add_f32_dpp v27, v27, v27 row_ror:8 row_mask:0xf bank_mask:0xf
  v_rcp_f32 v25, v25
  v_rcp_f32 v27, v27
  s_nop 0
  v_mul_f32 v24, v24, v25
  v_mul_f32 v26, v26, v27
  v_mul_f32 v108, v24, v108
  v_mul_f32 v109, v24, v109
  v_mul_f32 v110, v24, v110
  v_mul_f32 v111, v24, v111
  v_mul_f32 v40, v26, v40
  v_mul_f32 v41, v26, v41
  v_mul_f32 v42, v26, v42
  v_mul_f32 v43, v26, v43
  v_add_f32_dpp v108, v108, v108 row_ror:4 row_mask:0xf bank_mask:0xf
  v_add_f32_dpp v109, v109, v109 row_ror:4 row_mask:0xf bank_mask:0xf
  v_add_f32_dpp v110, v110, v110 row_ror:4 row_mask:0xf bank_mask:0xf
  v_add_f32_dpp v111, v111, v111 row_ror:4 row_mask:0xf bank_mask:0xf
  v_add_f32_dpp v40, v40, v40 row_ror:4 row_mask:0xf bank_mask:0xf
  v_add_f32_dpp v41, v41, v41 row_ror:4 row_mask:0xf bank_mask:0xf
  v_add_f32_dpp v42, v42, v42 row_ror:4 row_mask:0xf bank_mask:0xf
  v_add_f32_dpp v43, v43, v43 row_ror:4 row_mask:0xf bank_mask:0xf
  v_add_f32_dpp v108, v108, v108 row_ror:8 row_mask:0xf bank_mask:0xf
  v_add_f32_dpp v109, v109, v109 row_ror:8 row_mask:0xf bank_mask:0xf
  v_add_f32_dpp v110, v110, v110 row_ror:8 row_mask:0xf bank_mask:0xf
  v_add_f32_dpp v111, v111, v111 row_ror:8 row_mask:0xf bank_mask:0xf
  v_add_f32_dpp v40, v40, v40 row_ror:8 row_mask:0xf bank_mask:0xf
  v_add_f32_dpp v41, v41, v41 row_ror:8 row_mask:0xf bank_mask:0xf
  v_add_f32_dpp v42, v42, v42 row_ror:8 row_mask:0xf bank_mask:0xf
  v_add_f32_dpp v43, v43, v43 row_ror:8 row_mask:0xf bank_mask:0xf
  v_cvt_pk_bf16_f32 v108, v108, v108
  v_cvt_pk_bf16_f32 v109, v109, v109
  v_cvt_pk_bf16_f32 v110, v110, v110
  v_cvt_pk_bf16_f32 v111, v111, v111
  v_cvt_pk_bf16_f32 v40, v40, v40
  v_cvt_pk_bf16_f32 v41, v41, v41
  v_cvt_pk_bf16_f32 v42, v42, v42
  v_cvt_pk_bf16_f32 v43, v43, v43
  v_and_b32 v92, v108, v17
  v_and_b32 v93, v108, v18
  v_and_b32 v94, v109, v17
  v_and_b32 v95, v109, v18
  v_and_b32 v96, v110, v17
  v_and_b32 v97, v110, v18
  v_and_b32 v98, v111, v17
  v_and_b32 v99, v111, v18
  v_and_b32 v100, v40, v17
  v_and_b32 v101, v40, v18
  v_and_b32 v102, v41, v17
  v_and_b32 v103, v41, v18
  v_and_b32 v104, v42, v17
  v_and_b32 v105, v42, v18
  v_and_b32 v106, v43, v17
  v_and_b32 v107, v43, v18
  v_mov_b32 v10, 0
  s_mov_b64 exec, 1
  buffer_atomic_add v10, v19, s[40:43], s21 offen sc0 sc1
  s_mov_b64 exec, -1
  s_nop 0
  v_mfma_f32_16x16x16_bf16 v[52:55], v[112:113], v[92:93], 0
  v_mfma_f32_16x16x16_bf16 v[56:59], v[114:115], v[92:93], 0
  v_mfma_f32_16x16x16_bf16 v[60:63], v[112:113], v[100:101], 0
  v_mfma_f32_16x16x16_bf16 v[64:67], v[114:115], v[100:101], 0
  v_mfma_f32_16x16x16_bf16 v[52:55], v[116:117], v[94:95], v[52:55]
  v_mfma_f32_16x16x16_bf16 v[56:59], v[118:119], v[94:95], v[56:59]
  v_mfma_f32_16x16x16_bf16 v[60:63], v[116:117], v[102:103], v[60:63]
  v_mfma_f32_16x16x16_bf16 v[64:67], v[118:119], v[102:103], v[64:67]
  v_mfma_f32_16x16x16_bf16 v[52:55], v[120:121], v[96:97], v[52:55]
  v_mfma_f32_16x16x16_bf16 v[56:59], v[122:123], v[96:97], v[56:59]
  v_mfma_f32_16x16x16_bf16 v[60:63], v[120:121], v[104:105], v[60:63]
  v_mfma_f32_16x16x16_bf16 v[64:67], v[122:123], v[104:105], v[64:67]
  v_mfma_f32_16x16x16_bf16 v[52:55], v[124:125], v[98:99], v[52:55]
  v_mfma_f32_16x16x16_bf16 v[56:59], v[126:127], v[98:99], v[56:59]
  v_mfma_f32_16x16x16_bf16 v[60:63], v[124:125], v[106:107], v[60:63]
  v_mfma_f32_16x16x16_bf16 v[64:67], v[126:127], v[106:107], v[64:67]
  s_mul_i32 s62, s52, 6272
  v_add_u32 v16, s62, v4
  s_add_u32 s63, s99, 0
  s_nop 5
  ds_write_b32 v16, v52 offset:25600
  ds_write_b32 v16, v53 offset:25632
  ds_write_b32 v16, v54 offset:25664
  ds_write_b32 v16, v55 offset:25696
  ds_write_b32 v16, v56 offset:25616
  ds_write_b32 v16, v57 offset:25648
  ds_write_b32 v16, v58 offset:25680
  ds_write_b32 v16, v59 offset:25712
  ds_write_b32 v16, v60 offset:28736
  ds_write_b32 v16, v61 offset:28768
  ds_write_b32 v16, v62 offset:28800
  ds_write_b32 v16, v63 offset:28832
  ds_write_b32 v16, v64 offset:28752
  ds_write_b32 v16, v65 offset:28784
  ds_write_b32 v16, v66 offset:28816
  ds_write_b32 v16, v67 offset:28848
  s_waitcnt lgkmcnt(0)
  s_barrier
  s_waitcnt vmcnt(0)
  v_readfirstlane_b32 s22, v10
  s_nop 1
  s_cmp_ge_u32 s22, 64
  s_cselect_b32 s22, 1, 0
  s_cbranch_scc0 L_g1late
  s_add_u32 s66, s97, 524288
  s_add_u32 s67, s97, 557056
  s_add_u32 s27, s98, 8192
  buffer_load_dwordx2 v[84:85], v37, s[40:43], s27 offen sc1
  buffer_load_dwordx2 v[86:87], v37, s[40:43], s27 offen offset:512 sc1
  buffer_load_dwordx4 v[76:79], v36, s[40:43], s66 offen sc1
  buffer_load_dwordx4 v[80:83], v36, s[40:43], s67 offen sc1
L_g1late:
  ds_read_b128 v[52:55], v9 offset:25600
  ds_read_b128 v[56:59], v9 offset:31872
  ds_read_b128 v[60:63], v9 offset:38144
  ds_read_b128 v[64:67], v9 offset:44416
  s_waitcnt lgkmcnt(0)
  v_add_f32 v52, v52, v56
  v_add_f32 v60, v60, v64
  v_add_f32 v53, v53, v57
  v_add_f32 v61, v61, v65
  v_add_f32 v54, v54, v58
  v_add_f32 v62, v62, v66
  v_add_f32 v55, v55, v59
  v_add_f32 v63, v63, v67
  v_add_f32 v52, v52, v60
  v_add_f32 v53, v53, v61
  v_add_f32 v54, v54, v62
  v_add_f32 v55, v55, v63
  v_bfi_b32 v52, s60, v5, v52
  v_bfi_b32 v53, s60, v5, v53
  v_bfi_b32 v54, s60, v5, v54
  v_bfi_b32 v55, s60, v5, v55
  buffer_store_dwordx4 v[52:55], v38, s[40:43], s63 offen sc1
  s_cmp_eq_u32 s22, 1
  s_cbranch_scc1 L_g1have
  v_mov_b32 v10, 0
  s_mov_b64 exec, 1
  buffer_atomic_add v10, v19, s[40:43], s21 offen sc0 sc1
  s_mov_b64 exec, -1
  s_waitcnt vmcnt(0)
  s_mov_b32 s68, 4096
L_g1:
  v_readfirstlane_b32 s62, v10
  s_nop 1
  s_cmp_ge_u32 s62, 64
  s_cbranch_scc1 L_g1ok
  s_sub_u32 s68, s68, 1
  s_cmp_eq_u32 s68, 0
  s_cbranch_scc1 L_g1ok
  v_mov_b32 v10, 0
  s_mov_b64 exec, 1
  buffer_atomic_add v10, v19, s[40:43], s21 offen sc0 sc1
  s_mov_b64 exec, -1
  s_waitcnt vmcnt(0)
  s_branch L_g1
L_g1ok:
  s_add_u32 s66, s97, 524288
  s_add_u32 s67, s97, 557056
  s_add_u32 s27, s98, 8192
  buffer_load_dwordx2 v[84:85], v37, s[40:43], s27 offen sc1
  buffer_load_dwordx2 v[86:87], v37, s[40:43], s27 offen offset:512 sc1
  buffer_load_dwordx4 v[76:79], v36, s[40:43], s66 offen sc1
  buffer_load_dwordx4 v[80:83], v36, s[40:43], s67 offen sc1
  s_waitcnt vmcnt(0)
L_g1have:
  s_waitcnt vmcnt(1)
  s_mov_b32 s68, 0x40000
L_h11_chk:
  v_xor_b32 v15, v76, v5
  v_bitop3_b32 v15, v15, v77, v5 bitop3:0xf6
  v_bitop3_b32 v15, v15, v78, v5 bitop3:0xf6
  v_bitop3_b32 v15, v15, v79, v5 bitop3:0xf6
  v_bitop3_b32 v15, v15, v80, v5 bitop3:0xf6
  v_bitop3_b32 v15, v15, v81, v5 bitop3:0xf6
  v_bitop3_b32 v15, v15, v82, v5 bitop3:0xf6
  v_bitop3_b32 v15, v15, v83, v5 bitop3:0xf6
  v_bitop3_b32 v15, v15, v84, v5 bitop3:0xf6
  v_bitop3_b32 v15, v15, v86, v5 bitop3:0xf6
  v_and_b32 v15, 0xff, v15
  v_bitop3_b32 v15, v15, v85, v5 bitop3:0xf6
  v_bitop3_b32 v15, v15, v87, v5 bitop3:0xf6
  v_cmp_ne_u32 vcc, 0, v15
  s_cbranch_vccz L_h11_ok
  s_sub_u32 s68, s68, 1
  s_cmp_eq_u32 s68, 0
  s_cbranch_scc1 L_h11_ok
  s_mov_b64 exec, vcc
  s_add_u32 s66, s97, 524288
  s_add_u32 s67, s97, 557056
  s_add_u32 s27, s98, 8192
  buffer_load_dwordx2 v[84:85], v37, s[40:43], s27 offen sc1
  buffer_load_dwordx2 v[86:87], v37, s[40:43], s27 offen offset:512 sc1
  buffer_load_dwordx4 v[76:79], v36, s[40:43], s66 offen sc1
  buffer_load_dwordx4 v[80:83], v36, s[40:43], s67 offen sc1
  s_waitcnt vmcnt(0)
  s_branch L_h11_chk
L_h11_ok:
  s_mov_b64 exec, -1
  v_and_b32 v84, s61, v84
  v_and_b32 v86, s61, v86
  v_and_b32 v76, s61, v76
  v_and_b32 v77, s61, v77
  v_and_b32 v78, s61, v78
  v_and_b32 v79, s61, v79
  v_and_b32 v80, s61, v80
  v_and_b32 v81, s61, v81
  v_and_b32 v82, s61, v82
  v_and_b32 v83, s61, v83
  v_max_f32_dpp v15, v84, v84 row_ror:4 row_mask:0xf bank_mask:0xf
  v_max_f32_dpp v16, v86, v86 row_ror:4 row_mask:0xf bank_mask:0xf
  s_nop 0
  v_max_f32_dpp v15, v15, v15 row_ror:8 row_mask:0xf bank_mask:0xf
  v_max_f32_dpp v16, v16, v16 row_ror:8 row_mask:0xf bank_mask:0xf
  v_sub_f32 v84, v84, v15
  v_sub_f32 v86, v86, v16
  v_exp_f32 v84, v84
  v_exp_f32 v86, v86
  s_nop 1
  v_add_f32_dpp v85, v84, v84 row_ror:4 row_mask:0xf bank_mask:0xf
  v_add_f32_dpp v87, v86, v86 row_ror:4 row_mask:0xf bank_mask:0xf
  s_nop 0
  v_add_f32_dpp v85, v85, v85 row_ror:8 row_mask:0xf bank_mask:0xf
  v_add_f32_dpp v87, v87, v87 row_ror:8 row_mask:0xf bank_mask:0xf
  v_rcp_f32 v85, v85
  v_rcp_f32 v87, v87
  s_nop 0
  v_mul_f32 v84, v84, v85
  v_mul_f32 v86, v86, v87
  v_mul_f32 v76, v84, v76
  v_mul_f32 v77, v84, v77
  v_mul_f32 v78, v84, v78
  v_mul_f32 v79, v84, v79
  v_mul_f32 v80, v86, v80
  v_mul_f32 v81, v86, v81
  v_mul_f32 v82, v86, v82
  v_mul_f32 v83, v86, v83
  v_add_f32_dpp v76, v76, v76 row_ror:4 row_mask:0xf bank_mask:0xf
  v_add_f32_dpp v77, v77, v77 row_ror:4 row_mask:0xf bank_mask:0xf
  v_add_f32_dpp v78, v78, v78 row_ror:4 row_mask:0xf bank_mask:0xf
  v_add_f32_dpp v79, v79, v79 row_ror:4 row_mask:0xf bank_mask:0xf
  v_add_f32_dpp v80, v80, v80 row_ror:4 row_mask:0xf bank_mask:0xf
  v_add_f32_dpp v81, v81, v81 row_ror:4 row_mask:0xf bank_mask:0xf
  v_add_f32_dpp v82, v82, v82 row_ror:4 row_mask:0xf bank_mask:0xf
  v_add_f32_dpp v83, v83, v83 row_ror:4 row_mask:0xf bank_mask:0xf
  v_add_f32_dpp v76, v76, v76 row_ror:8 row_mask:0xf bank_mask:0xf
  v_add_f32_dpp v77, v77, v77 row_ror:8 row_mask:0xf bank_mask:0xf
  v_add_f32_dpp v78, v78, v78 row_ror:8 row_mask:0xf bank_mask:0xf
  v_add_f32_dpp v79, v79, v79 row_ror:8 row_mask:0xf bank_mask:0xf
  v_add_f32_dpp v80, v80, v80 row_ror:8 row_mask:0xf bank_mask:0xf
  v_add_f32_dpp v81, v81, v81 row_ror:8 row_mask:0xf bank_mask:0xf
  v_add_f32_dpp v82, v82, v82 row_ror:8 row_mask:0xf bank_mask:0xf
  v_add_f32_dpp v83, v83, v83 row_ror:8 row_mask:0xf bank_mask:0xf
  v_cvt_pk_bf16_f32 v76, v76, v76
  v_cvt_pk_bf16_f32 v77, v77, v77
  v_cvt_pk_bf16_f32 v78, v78, v78
  v_cvt_pk_bf16_f32 v79, v79, v79
  v_cvt_pk_bf16_f32 v80, v80, v80
  v_cvt_pk_bf16_f32 v81, v81, v81
  v_cvt_pk_bf16_f32 v82, v82, v82
  v_cvt_pk_bf16_f32 v83, v83, v83
  v_and_b32 v92, v76, v17
  v_and_b32 v93, v76, v18
  v_and_b32 v94, v77, v17
  v_and_b32 v95, v77, v18
  v_and_b32 v96, v78, v17
  v_and_b32 v97, v78, v18
  v_and_b32 v98, v79, v17
  v_and_b32 v99, v79, v18
  v_and_b32 v100, v80, v17
  v_and_b32 v101, v80, v18
  v_and_b32 v102, v81, v17
  v_and_b32 v103, v81, v18
  v_and_b32 v104, v82, v17
  v_and_b32 v105, v82, v18
  v_and_b32 v106, v83, v17
  v_and_b32 v107, v83, v18
  v_mov_b32 v15, 1
  s_mov_b64 exec, 1
  buffer_atomic_add v15, v19, s[40:43], s9 offen sc1
  s_mov_b64 exec, -1
  s_nop 0
  v_mfma_f32_16x16x16_bf16 v[52:55], a[0:1], v[92:93], 0
  v_mfma_f32_16x16x16_bf16 v[56:59], a[2:3], v[92:93], 0
  v_mfma_f32_16x16x16_bf16 v[60:63], a[0:1], v[100:101], 0
  v_mfma_f32_16x16x16_bf16 v[64:67], a[2:3], v[100:101], 0
  v_mfma_f32_16x16x16_bf16 v[52:55], a[4:5], v[94:95], v[52:55]
  v_mfma_f32_16x16x16_bf16 v[56:59], a[6:7], v[94:95], v[56:59]
  v_mfma_f32_16x16x16_bf16 v[60:63], a[4:5], v[102:103], v[60:63]
  v_mfma_f32_16x16x16_bf16 v[64:67], a[6:7], v[102:103], v[64:67]
  v_mfma_f32_16x16x16_bf16 v[52:55], a[8:9], v[96:97], v[52:55]
  v_mfma_f32_16x16x16_bf16 v[56:59], a[10:11], v[96:97], v[56:59]
  v_mfma_f32_16x16x16_bf16 v[60:63], a[8:9], v[104:105], v[60:63]
  v_mfma_f32_16x16x16_bf16 v[64:67], a[10:11], v[104:105], v[64:67]
  v_mfma_f32_16x16x16_bf16 v[52:55], a[12:13], v[98:99], v[52:55]
  v_mfma_f32_16x16x16_bf16 v[56:59], a[14:15], v[98:99], v[56:59]
  v_mfma_f32_16x16x16_bf16 v[60:63], a[12:13], v[106:107], v[60:63]
  v_mfma_f32_16x16x16_bf16 v[64:67], a[14:15], v[106:107], v[64:67]
  s_mul_i32 s62, s52, 6272
  v_add_u32 v16, s62, v4
  s_add_u32 s63, s99, 1048576
  s_nop 5
  ds_write_b32 v16, v52 offset:0
  ds_write_b32 v16, v53 offset:32
  ds_write_b32 v16, v54 offset:64
  ds_write_b32 v16, v55 offset:96
  ds_write_b32 v16, v56 offset:16
  ds_write_b32 v16, v57 offset:48
  ds_write_b32 v16, v58 offset:80
  ds_write_b32 v16, v59 offset:112
  ds_write_b32 v16, v60 offset:3136
  ds_write_b32 v16, v61 offset:3168
  ds_write_b32 v16, v62 offset:3200
  ds_write_b32 v16, v63 offset:3232
  ds_write_b32 v16, v64 offset:3152
  ds_write_b32 v16, v65 offset:3184
  ds_write_b32 v16, v66 offset:3216
  ds_write_b32 v16, v67 offset:3248
  s_waitcnt lgkmcnt(0)
  s_barrier
  ds_read_b128 v[52:55], v9 offset:0
  ds_read_b128 v[56:59], v9 offset:6272
  ds_read_b128 v[60:63], v9 offset:12544
  ds_read_b128 v[64:67], v9 offset:18816
  s_waitcnt lgkmcnt(0)
  v_add_f32 v52, v52, v56
  v_add_f32 v60, v60, v64
  v_add_f32 v53, v53, v57
  v_add_f32 v61, v61, v65
  v_add_f32 v54, v54, v58
  v_add_f32 v62, v62, v66
  v_add_f32 v55, v55, v59
  v_add_f32 v63, v63, v67
  v_add_f32 v52, v52, v60
  v_add_f32 v53, v53, v61
  v_add_f32 v54, v54, v62
  v_add_f32 v55, v55, v63
  v_bfi_b32 v52, s60, v5, v52
  v_bfi_b32 v53, s60, v5, v53
  v_bfi_b32 v54, s60, v5, v54
  v_bfi_b32 v55, s60, v5, v55
  buffer_store_dwordx4 v[52:55], v38, s[40:43], s63 offen sc1
  s_cmp_lg_u32 s52, 0
  s_cbranch_scc1 L_fin
  s_lshr_b32 s62, s2, 7
  s_bfe_u32 s63, s2, 0x30004
  s_bfe_u32 s64, s2, 0x20002
  s_lshl_b32 s65, s62, 2
  s_add_u32 s65, s65, s64
  s_lshl_b32 s65, s65, 18
  s_lshl_b32 s66, s63, 9
  s_add_u32 s65, s65, s66
  s_lshl_b32 s66, s72, 7
  s_add_u32 s65, s65, s66
  s_add_u32 s65, s65, 2228224
  v_lshrrev_b32 v68, 3, v1
  v_lshlrev_b32 v68, 12, v68
  v_and_b32 v69, 7, v1
  v_lshl_add_u32 v68, v69, 4, v68
  s_lshl_b32 s66, s63, 11
  s_lshl_b32 s67, s62, 10
  s_add_u32 s66, s66, s67
  s_lshl_b32 s67, s64, 8
  s_add_u32 s66, s66, s67
  s_lshl_b32 s67, s72, 6
  s_add_u32 s67, s66, s67
  s_mov_b32 s44, s24
  s_and_b32 s45, s25, 0xffff
  s_mov_b32 s46, 0x4000
  s_mov_b32 s47, 0x20000
  v_lshlrev_b32 v69, 3, v69
  s_cmp_lt_u32 s2, 128
  s_cbranch_scc1 L_g2ok
  s_lshl_b32 s66, s64, 11
  s_add_u32 s27, s66, 4325376
  v_lshlrev_b32 v70, 8, v1
  s_mov_b32 s68, 4096
L_g2:
  v_mov_b32 v71, 0
  s_mov_b64 exec, 0xff
  buffer_atomic_add v71, v70, s[40:43], s27 offen sc0 sc1
  s_waitcnt vmcnt(0)
  v_cmp_gt_u32 vcc, 32, v71
  s_mov_b64 exec, -1
  s_cbranch_vccz L_g2ok
  s_sub_u32 s68, s68, 1
  s_cmp_lg_u32 s68, 0
  s_cbranch_scc1 L_g2
L_g2ok:
  s_mov_b32 s66, s65
  buffer_load_dwordx4 v[76:79], v68, s[40:43], s66 offen sc1
  s_add_u32 s66, s66, 32768
  buffer_load_dwordx4 v[80:83], v68, s[40:43], s66 offen sc1
  s_add_u32 s66, s66, 32768
  buffer_load_dwordx4 v[84:87], v68, s[40:43], s66 offen sc1
  s_add_u32 s66, s66, 32768
  buffer_load_dwordx4 v[88:91], v68, s[40:43], s66 offen sc1
  s_add_u32 s66, s66, 32768
  buffer_load_dwordx4 v[92:95], v68, s[40:43], s66 offen sc1
  s_add_u32 s66, s66, 32768
  buffer_load_dwordx4 v[96:99], v68, s[40:43], s66 offen sc1
  s_add_u32 s66, s66, 32768
  buffer_load_dwordx4 v[100:103], v68, s[40:43], s66 offen sc1
  s_add_u32 s66, s66, 32768
  buffer_load_dwordx4 v[104:107], v68, s[40:43], s66 offen sc1
  s_waitcnt vmcnt(0)
  s_mov_b32 s68, 0x40000
L_h2E_chk:
  v_xor_b32 v15, v76, v5
  v_bitop3_b32 v15, v15, v77, v5 bitop3:0xf6
  v_bitop3_b32 v15, v15, v78, v5 bitop3:0xf6
  v_bitop3_b32 v15, v15, v79, v5 bitop3:0xf6
  v_bitop3_b32 v15, v15, v80, v5 bitop3:0xf6
  v_bitop3_b32 v15, v15, v81, v5 bitop3:0xf6
  v_bitop3_b32 v15, v15, v82, v5 bitop3:0xf6
  v_bitop3_b32 v15, v15, v83, v5 bitop3:0xf6
  v_bitop3_b32 v15, v15, v84, v5 bitop3:0xf6
  v_bitop3_b32 v15, v15, v85, v5 bitop3:0xf6
  v_bitop3_b32 v15, v15, v86, v5 bitop3:0xf6
  v_bitop3_b32 v15, v15, v87, v5 bitop3:0xf6
  v_bitop3_b32 v15, v15, v88, v5 bitop3:0xf6
  v_bitop3_b32 v15, v15, v89, v5 bitop3:0xf6
  v_bitop3_b32 v15, v15, v90, v5 bitop3:0xf6
  v_bitop3_b32 v15, v15, v91, v5 bitop3:0xf6
  v_bitop3_b32 v15, v15, v92, v5 bitop3:0xf6
  v_bitop3_b32 v15, v15, v93, v5 bitop3:0xf6
  v_bitop3_b32 v15, v15, v94, v5 bitop3:0xf6
  v_bitop3_b32 v15, v15, v95, v5 bitop3:0xf6
  v_bitop3_b32 v15, v15, v96, v5 bitop3:0xf6
  v_bitop3_b32 v15, v15, v97, v5 bitop3:0xf6
  v_bitop3_b32 v15, v15, v98, v5 bitop3:0xf6
  v_bitop3_b32 v15, v15, v99, v5 bitop3:0xf6
  v_bitop3_b32 v15, v15, v100, v5 bitop3:0xf6
  v_bitop3_b32 v15, v15, v101, v5 bitop3:0xf6
  v_bitop3_b32 v15, v15, v102, v5 bitop3:0xf6
  v_bitop3_b32 v15, v15, v103, v5 bitop3:0xf6
  v_bitop3_b32 v15, v15, v104, v5 bitop3:0xf6
  v_bitop3_b32 v15, v15, v105, v5 bitop3:0xf6
  v_bitop3_b32 v15, v15, v106, v5 bitop3:0xf6
  v_bitop3_b32 v15, v15, v107, v5 bitop3:0xf6
  v_and_b32 v15, 0xff, v15
  v_cmp_ne_u32 vcc, 0, v15
  s_cbranch_vccz L_h2E_ok
  s_sub_u32 s68, s68, 1
  s_cmp_eq_u32 s68, 0
  s_cbranch_scc1 L_h2E_ok
  s_mov_b32 s66, s65
  buffer_load_dwordx4 v[76:79], v68, s[40:43], s66 offen sc1
  s_add_u32 s66, s66, 32768
  buffer_load_dwordx4 v[80:83], v68, s[40:43], s66 offen sc1
  s_add_u32 s66, s66, 32768
  buffer_load_dwordx4 v[84:87], v68, s[40:43], s66 offen sc1
  s_add_u32 s66, s66, 32768
  buffer_load_dwordx4 v[88:91], v68, s[40:43], s66 offen sc1
  s_add_u32 s66, s66, 32768
  buffer_load_dwordx4 v[92:95], v68, s[40:43], s66 offen sc1
  s_add_u32 s66, s66, 32768
  buffer_load_dwordx4 v[96:99], v68, s[40:43], s66 offen sc1
  s_add_u32 s66, s66, 32768
  buffer_load_dwordx4 v[100:103], v68, s[40:43], s66 offen sc1
  s_add_u32 s66, s66, 32768
  buffer_load_dwordx4 v[104:107], v68, s[40:43], s66 offen sc1
  s_waitcnt vmcnt(0)
  s_branch L_h2E_chk
L_h2E_ok:
  v_and_b32 v76, s61, v76
  v_and_b32 v77, s61, v77
  v_and_b32 v78, s61, v78
  v_and_b32 v79, s61, v79
  v_and_b32 v80, s61, v80
  v_and_b32 v81, s61, v81
  v_and_b32 v82, s61, v82
  v_and_b32 v83, s61, v83
  v_and_b32 v84, s61, v84
  v_and_b32 v85, s61, v85
  v_and_b32 v86, s61, v86
  v_and_b32 v87, s61, v87
  v_and_b32 v88, s61, v88
  v_and_b32 v89, s61, v89
  v_and_b32 v90, s61, v90
  v_and_b32 v91, s61, v91
  v_and_b32 v92, s61, v92
  v_and_b32 v93, s61, v93
  v_and_b32 v94, s61, v94
  v_and_b32 v95, s61, v95
  v_and_b32 v96, s61, v96
  v_and_b32 v97, s61, v97
  v_and_b32 v98, s61, v98
  v_and_b32 v99, s61, v99
  v_and_b32 v100, s61, v100
  v_and_b32 v101, s61, v101
  v_and_b32 v102, s61, v102
  v_and_b32 v103, s61, v103
  v_and_b32 v104, s61, v104
  v_and_b32 v105, s61, v105
  v_and_b32 v106, s61, v106
  v_and_b32 v107, s61, v107
  v_add_f32 v76, v76, v92
  v_add_f32 v77, v77, v93
  v_add_f32 v78, v78, v94
  v_add_f32 v79, v79, v95
  v_add_f32 v80, v80, v96
  v_add_f32 v81, v81, v97
  v_add_f32 v82, v82, v98
  v_add_f32 v83, v83, v99
  v_add_f32 v84, v84, v100
  v_add_f32 v85, v85, v101
  v_add_f32 v86, v86, v102
  v_add_f32 v87, v87, v103
  v_add_f32 v88, v88, v104
  v_add_f32 v89, v89, v105
  v_add_f32 v90, v90, v106
  v_add_f32 v91, v91, v107
  v_add_f32 v76, v76, v84
  v_add_f32 v77, v77, v85
  v_add_f32 v78, v78, v86
  v_add_f32 v79, v79, v87
  v_add_f32 v80, v80, v88
  v_add_f32 v81, v81, v89
  v_add_f32 v82, v82, v90
  v_add_f32 v83, v83, v91
  v_add_f32 v76, v76, v80
  v_add_f32 v77, v77, v81
  v_add_f32 v78, v78, v82
  v_add_f32 v79, v79, v83
  s_nop 0
  v_add_f32_dpp v76, v76, v76 row_ror:8 row_mask:0xf bank_mask:0xf
  v_add_f32_dpp v77, v77, v77 row_ror:8 row_mask:0xf bank_mask:0xf
  v_add_f32_dpp v78, v78, v78 row_ror:8 row_mask:0xf bank_mask:0xf
  v_add_f32_dpp v79, v79, v79 row_ror:8 row_mask:0xf bank_mask:0xf
  v_mov_b32 v80, v76
  v_mov_b32 v81, v77
  v_mov_b32 v82, v78
  v_mov_b32 v83, v79
  s_nop 1
  v_permlane16_swap_b32 v76, v80
  v_permlane16_swap_b32 v77, v81
  v_permlane16_swap_b32 v78, v82
  v_permlane16_swap_b32 v79, v83
  s_nop 1
  v_add_f32 v76, v76, v80
  v_add_f32 v77, v77, v81
  v_add_f32 v78, v78, v82
  v_add_f32 v79, v79, v83
  v_mov_b32 v80, v76
  v_mov_b32 v81, v77
  v_mov_b32 v82, v78
  v_mov_b32 v83, v79
  s_nop 1
  v_permlane32_swap_b32 v76, v80
  v_permlane32_swap_b32 v77, v81
  v_permlane32_swap_b32 v78, v82
  v_permlane32_swap_b32 v79, v83
  s_nop 1
  v_add_f32 v76, v76, v80
  v_add_f32 v77, v77, v81
  v_add_f32 v78, v78, v82
  v_add_f32 v79, v79, v83
  v_cvt_pk_bf16_f32 v84, v76, v77
  v_cvt_pk_bf16_f32 v85, v78, v79
  s_mov_b64 exec, 0xff
  buffer_store_dwordx2 v[84:85], v69, s[44:47], s67 offen
  s_mov_b64 exec, -1
  s_cmp_lg_u32 s2, 0
  s_cbranch_scc1 L_fin
  s_mov_b64 exec, 1
  buffer_store_dword v5, v19, s[40:43], 0 offen offset:0 sc1
L_fin:
  s_endpgm
L_rare0:
  v_mov_b32 v15, v11
  s_nop 1
  v_max_f32_dpp v15, v15, v15 row_ror:4 row_mask:0xf bank_mask:0xf
  s_nop 1
  v_max_f32_dpp v15, v15, v15 row_ror:8 row_mask:0xf bank_mask:0xf
  v_mov_b32 v16, v15
  s_nop 1
  v_permlane16_swap_b32 v15, v16
  s_nop 1
  v_max_f32 v15, v15, v16
  v_mov_b32 v16, v15
  s_nop 1
  v_permlane32_swap_b32 v15, v16
  s_nop 1
  v_max_f32 v15, v15, v16
  v_max_f32 v15, v15, v6
  v_sub_f32 v16, v6, v15
  v_mul_f32 v16, s59, v16
  v_exp_f32 v16, v16
  v_mov_b32 v6, v15
  v_mul_f32 v7, s59, v15
  v_mul_f32 v8, v8, v16
  v_mul_f32 v28, v28, v16
  v_mul_f32 v29, v29, v16
  v_mul_f32 v30, v30, v16
  v_mul_f32 v31, v31, v16
  v_mul_f32 v32, v32, v16
  v_mul_f32 v33, v33, v16
  v_mul_f32 v34, v34, v16
  v_mul_f32 v35, v35, v16
  s_branch L_cont0
L_rare1:
  v_mov_b32 v15, v11
  s_nop 1
  v_max_f32_dpp v15, v15, v15 row_ror:4 row_mask:0xf bank_mask:0xf
  s_nop 1
  v_max_f32_dpp v15, v15, v15 row_ror:8 row_mask:0xf bank_mask:0xf
  v_mov_b32 v16, v15
  s_nop 1
  v_permlane16_swap_b32 v15, v16
  s_nop 1
  v_max_f32 v15, v15, v16
  v_mov_b32 v16, v15
  s_nop 1
  v_permlane32_swap_b32 v15, v16
  s_nop 1
  v_max_f32 v15, v15, v16
  v_max_f32 v15, v15, v6
  v_sub_f32 v16, v6, v15
  v_mul_f32 v16, s59, v16
  v_exp_f32 v16, v16
  v_mov_b32 v6, v15
  v_mul_f32 v7, s59, v15
  v_mul_f32 v8, v8, v16
  v_mul_f32 v28, v28, v16
  v_mul_f32 v29, v29, v16
  v_mul_f32 v30, v30, v16
  v_mul_f32 v31, v31, v16
  v_mul_f32 v32, v32, v16
  v_mul_f32 v33, v33, v16
  v_mul_f32 v34, v34, v16
  v_mul_f32 v35, v35, v16
  s_branch L_cont1
L_rare2:
  v_mov_b32 v15, v11
  s_nop 1
  v_max_f32_dpp v15, v15, v15 row_ror:4 row_mask:0xf bank_mask:0xf
  s_nop 1
  v_max_f32_dpp v15, v15, v15 row_ror:8 row_mask:0xf bank_mask:0xf
  v_mov_b32 v16, v15
  s_nop 1
  v_permlane16_swap_b32 v15, v16
  s_nop 1
  v_max_f32 v15, v15, v16
  v_mov_b32 v16, v15
  s_nop 1
  v_permlane32_swap_b32 v15, v16
  s_nop 1
  v_max_f32 v15, v15, v16
  v_max_f32 v15, v15, v6
  v_sub_f32 v16, v6, v15
  v_mul_f32 v16, s59, v16
  v_exp_f32 v16, v16
  v_mov_b32 v6, v15
  v_mul_f32 v7, s59, v15
  v_mul_f32 v8, v8, v16
  v_mul_f32 v28, v28, v16
  v_mul_f32 v29, v29, v16
  v_mul_f32 v30, v30, v16
  v_mul_f32 v31, v31, v16
  v_mul_f32 v32, v32, v16
  v_mul_f32 v33, v33, v16
  v_mul_f32 v34, v34, v16
  v_mul_f32 v35, v35, v16
  s_branch L_cont2
L_rare3:
  v_mov_b32 v15, v11
  s_nop 1
  v_max_f32_dpp v15, v15, v15 row_ror:4 row_mask:0xf bank_mask:0xf
  s_nop 1
  v_max_f32_dpp v15, v15, v15 row_ror:8 row_mask:0xf bank_mask:0xf
  v_mov_b32 v16, v15
  s_nop 1
  v_permlane16_swap_b32 v15, v16
  s_nop 1
  v_max_f32 v15, v15, v16
  v_mov_b32 v16, v15
  s_nop 1
  v_permlane32_swap_b32 v15, v16
  s_nop 1
  v_max_f32 v15, v15, v16
  v_max_f32 v15, v15, v6
  v_sub_f32 v16, v6, v15
  v_mul_f32 v16, s59, v16
  v_exp_f32 v16, v16
  v_mov_b32 v6, v15
  v_mul_f32 v7, s59, v15
  v_mul_f32 v8, v8, v16
  v_mul_f32 v28, v28, v16
  v_mul_f32 v29, v29, v16
  v_mul_f32 v30, v30, v16
  v_mul_f32 v31, v31, v16
  v_mul_f32 v32, v32, v16
  v_mul_f32 v33, v33, v16
  v_mul_f32 v34, v34, v16
  v_mul_f32 v35, v35, v16
  s_branch L_cont3
L_late1:
  buffer_load_dwordx4 a[0:3], v2, s[32:35], s53 offen offset:0 nt
  buffer_load_dwordx4 a[4:7], v2, s[32:35], s53 offen offset:1024 nt
  buffer_load_dwordx4 a[8:11], v2, s[32:35], s53 offen offset:2048 nt
  buffer_load_dwordx4 a[12:15], v2, s[32:35], s53 offen offset:3072 nt
  buffer_load_dwordx4 a[16:19], v3, s[36:39], s53 offen offset:0 nt
  buffer_load_dwordx4 a[20:23], v3, s[36:39], s53 offen offset:1024 nt
  buffer_load_dwordx4 a[24:27], v3, s[36:39], s53 offen offset:2048 nt
  buffer_load_dwordx4 a[28:31], v3, s[36:39], s53 offen offset:3072 nt
  s_add_u32 s53, s53, s69
  s_add_u32 s55, s55, 1
  s_cmp_eq_u32 s55, 8
  s_cselect_b32 s53, s54, s53
  s_cselect_b32 s69, 0x10000, s69
  s_cselect_b32 s32, s16, s32
  s_cselect_b32 s33, s17, s33
  s_cselect_b32 s36, s18, s36
  s_cselect_b32 s37, s19, s37
  s_branch L_noiss1
L_wait0:
  s_cmp_eq_u32 s62, 2
  s_cbranch_scc1 L_wait0_2
  s_cmp_eq_u32 s62, 3
  s_cbranch_scc1 L_wait0_3
  s_waitcnt vmcnt(24)
  s_branch L_nowait0
L_wait0_2:
  s_waitcnt vmcnt(8)
  s_branch L_nowait0
L_wait0_3:
  s_waitcnt vmcnt(16)
  s_branch L_nowait0
L_wait1:
  s_cmp_eq_u32 s62, 2
  s_cbranch_scc1 L_wait1_2
  s_cmp_eq_u32 s62, 3
  s_cbranch_scc1 L_wait1_3
  s_waitcnt vmcnt(24)
  s_branch L_nowait1
L_wait1_2:
  s_waitcnt vmcnt(8)
  s_branch L_nowait1
L_wait1_3:
  s_waitcnt vmcnt(16)
  s_branch L_nowait1
L_wait2:
  s_cmp_eq_u32 s62, 2
  s_cbranch_scc1 L_wait2_2
  s_cmp_eq_u32 s62, 3
  s_cbranch_scc1 L_wait2_3
  s_waitcnt vmcnt(24)
  s_branch L_nowait2
L_wait2_2:
  s_waitcnt vmcnt(8)
  s_branch L_nowait2
L_wait2_3:
  s_waitcnt vmcnt(16)
  s_branch L_nowait2
L_wait3:
  s_cmp_eq_u32 s62, 2
  s_cbranch_scc1 L_wait3_2
  s_cmp_eq_u32 s62, 3
  s_cbranch_scc1 L_wait3_3
  s_waitcnt vmcnt(24)
  s_branch L_nowait3
L_wait3_2:
  s_waitcnt vmcnt(8)
  s_branch L_nowait3
L_wait3_3:
  s_waitcnt vmcnt(16)
  s_branch L_nowait3
L_dyn0:
  s_cmp_lt_u32 s55, 32
  s_cbranch_scc1 L_claim0
  s_cmp_lg_u32 s75, -1
  s_cbranch_scc1 L_noiss0
  v_readfirstlane_b32 s63, v10
  s_nop 1
  s_add_u32 s63, s63, 384
  s_cmp_lt_u32 s63, 512
  s_cbranch_scc1 L_got0
  s_cmp_lg_u32 s31, 0
  s_cbranch_scc1 L_nopre0
  s_mov_b32 s31, 1
  buffer_load_dwordx4 v[112:115], v39, s[44:47], s26 offen offset:0 nt
  buffer_load_dwordx4 v[116:119], v39, s[44:47], s26 offen offset:1024 nt
  buffer_load_dwordx4 v[120:123], v39, s[44:47], s26 offen offset:2048 nt
  buffer_load_dwordx4 v[124:127], v39, s[44:47], s26 offen offset:3072 nt
  s_add_u32 s66, s97, 0
  s_add_u32 s67, s97, 32768
  s_add_u32 s27, s98, 0
  buffer_load_dwordx2 v[24:25], v37, s[40:43], s27 offen sc1
  buffer_load_dwordx2 v[26:27], v37, s[40:43], s27 offen offset:512 sc1
  buffer_load_dwordx4 v[108:111], v36, s[40:43], s66 offen sc1
  buffer_load_dwordx4 v[40:43], v36, s[40:43], s67 offen sc1
L_nopre0:
  s_cmp_lt_u32 s63, 512
  s_cbranch_scc1 L_got0
  s_mov_b32 s75, s55
  s_branch L_noiss0
L_got0:
  s_lshl_b32 s63, s63, 12
  s_add_u32 s53, s74, s63
L_claim0:
  v_mov_b32 v10, 1
  s_mov_b64 exec, 1
  buffer_atomic_add v10, v19, s[40:43], s96 offen sc0 sc1
  s_mov_b64 exec, -1
  s_branch L_loads0
L_dyn1:
  s_cmp_lt_u32 s55, 32
  s_cbranch_scc1 L_claim1
  s_cmp_lg_u32 s75, -1
  s_cbranch_scc1 L_noiss1
  v_readfirstlane_b32 s63, v10
  s_nop 1
  s_add_u32 s63, s63, 384
  s_cmp_lt_u32 s63, 512
  s_cbranch_scc1 L_got1
  s_cmp_lg_u32 s31, 0
  s_cbranch_scc1 L_nopre1
  s_mov_b32 s31, 1
  buffer_load_dwordx4 v[112:115], v39, s[44:47], s26 offen offset:0 nt
  buffer_load_dwordx4 v[116:119], v39, s[44:47], s26 offen offset:1024 nt
  buffer_load_dwordx4 v[120:123], v39, s[44:47], s26 offen offset:2048 nt
  buffer_load_dwordx4 v[124:127], v39, s[44:47], s26 offen offset:3072 nt
  s_add_u32 s66, s97, 0
  s_add_u32 s67, s97, 32768
  s_add_u32 s27, s98, 0
  buffer_load_dwordx2 v[24:25], v37, s[40:43], s27 offen sc1
  buffer_load_dwordx2 v[26:27], v37, s[40:43], s27 offen offset:512 sc1
  buffer_load_dwordx4 v[108:111], v36, s[40:43], s66 offen sc1
  buffer_load_dwordx4 v[40:43], v36, s[40:43], s67 offen sc1
L_nopre1:
  s_cmp_lt_u32 s63, 512
  s_cbranch_scc1 L_got1
  s_mov_b32 s75, s55
  s_branch L_noiss1
L_got1:
  s_lshl_b32 s63, s63, 12
  s_add_u32 s53, s74, s63
L_claim1:
  v_mov_b32 v10, 1
  s_mov_b64 exec, 1
  buffer_atomic_add v10, v19, s[40:43], s96 offen sc0 sc1
  s_mov_b64 exec, -1
  s_branch L_loads1
L_dyn2:
  s_cmp_lt_u32 s55, 32
  s_cbranch_scc1 L_claim2
  s_cmp_lg_u32 s75, -1
  s_cbranch_scc1 L_noiss2
  v_readfirstlane_b32 s63, v10
  s_nop 1
  s_add_u32 s63, s63, 384
  s_cmp_lt_u32 s63, 512
  s_cbranch_scc1 L_got2
  s_cmp_lg_u32 s31, 0
  s_cbranch_scc1 L_nopre2
  s_mov_b32 s31, 1
  buffer_load_dwordx4 v[112:115], v39, s[44:47], s26 offen offset:0 nt
  buffer_load_dwordx4 v[116:119], v39, s[44:47], s26 offen offset:1024 nt
  buffer_load_dwordx4 v[120:123], v39, s[44:47], s26 offen offset:2048 nt
  buffer_load_dwordx4 v[124:127], v39, s[44:47], s26 offen offset:3072 nt
  s_add_u32 s66, s97, 0
  s_add_u32 s67, s97, 32768
  s_add_u32 s27, s98, 0
  buffer_load_dwordx2 v[24:25], v37, s[40:43], s27 offen sc1
  buffer_load_dwordx2 v[26:27], v37, s[40:43], s27 offen offset:512 sc1
  buffer_load_dwordx4 v[108:111], v36, s[40:43], s66 offen sc1
  buffer_load_dwordx4 v[40:43], v36, s[40:43], s67 offen sc1
L_nopre2:
  s_cmp_lt_u32 s63, 512
  s_cbranch_scc1 L_got2
  s_mov_b32 s75, s55
  s_branch L_noiss2
L_got2:
  s_lshl_b32 s63, s63, 12
  s_add_u32 s53, s74, s63
L_claim2:
  v_mov_b32 v10, 1
  s_mov_b64 exec, 1
  buffer_atomic_add v10, v19, s[40:43], s96 offen sc0 sc1
  s_mov_b64 exec, -1
  s_branch L_loads2
L_dyn3:
  s_cmp_lt_u32 s55, 32
  s_cbranch_scc1 L_claim3
  s_cmp_lg_u32 s75, -1
  s_cbranch_scc1 L_noiss3
  v_readfirstlane_b32 s63, v10
  s_nop 1
  s_add_u32 s63, s63, 384
  s_cmp_lt_u32 s63, 512
  s_cbranch_scc1 L_got3
  s_cmp_lg_u32 s31, 0
  s_cbranch_scc1 L_nopre3
  s_mov_b32 s31, 1
  buffer_load_dwordx4 v[112:115], v39, s[44:47], s26 offen offset:0 nt
  buffer_load_dwordx4 v[116:119], v39, s[44:47], s26 offen offset:1024 nt
  buffer_load_dwordx4 v[120:123], v39, s[44:47], s26 offen offset:2048 nt
  buffer_load_dwordx4 v[124:127], v39, s[44:47], s26 offen offset:3072 nt
  s_add_u32 s66, s97, 0
  s_add_u32 s67, s97, 32768
  s_add_u32 s27, s98, 0
  buffer_load_dwordx2 v[24:25], v37, s[40:43], s27 offen sc1
  buffer_load_dwordx2 v[26:27], v37, s[40:43], s27 offen offset:512 sc1
  buffer_load_dwordx4 v[108:111], v36, s[40:43], s66 offen sc1
  buffer_load_dwordx4 v[40:43], v36, s[40:43], s67 offen sc1
L_nopre3:
  s_cmp_lt_u32 s63, 512
  s_cbranch_scc1 L_got3
  s_mov_b32 s75, s55
  s_branch L_noiss3
L_got3:
  s_lshl_b32 s63, s63, 12
  s_add_u32 s53, s74, s63
L_claim3:
  v_mov_b32 v10, 1
  s_mov_b64 exec, 1
  buffer_atomic_add v10, v19, s[40:43], s96 offen sc0 sc1
  s_mov_b64 exec, -1
  s_branch L_loads3
L_end:
  s_endpgm
.section .rodata,"a"
.p2align 6
.amdhsa_kernel concat_heads__sliding_block_cached__gqa_block_cached__decode_kernel
  .amdhsa_next_free_vgpr 256
  .amdhsa_next_free_sgpr 102
  .amdhsa_accum_offset 128
  .amdhsa_group_segment_fixed_size 0
  .amdhsa_kernarg_size 104
  .amdhsa_user_sgpr_count 2
  .amdhsa_user_sgpr_kernarg_segment_ptr 1
  .amdhsa_system_sgpr_workgroup_id_x 1
  .amdhsa_float_denorm_mode_32 3
.end_amdhsa_kernel
```
